```python
import torch

def _softmax(x, axis=-1):
    return torch.softmax(x, dim=axis)
def _gelu(x):
    return torch.nn.functional.gelu(x, approximate="tanh")
def _silu(x):
    return torch.nn.functional.silu(x)
def _sigmoid(x):
    return torch.sigmoid(x)
def _layernorm(x, axis=-1, eps=1e-5):
    m = x.mean(dim=axis, keepdim=True)
    v = x.var(dim=axis, keepdim=True, unbiased=False)
    return (x - m) / torch.sqrt(v + eps)
def _scatter_add(tgt, idx, src, axis=0):
    return tgt.clone().index_add_(axis, idx, src)
def _segment_sum(src, seg, n):
    out = torch.zeros((n,) + src.shape[1:], dtype=src.dtype)
    return out.index_add_(0, seg, src)
def _pad(x, pw):
    flat = tuple(v for pair in reversed(pw) for v in pair)
    return torch.nn.functional.pad(x, flat)

kernel_name = 'concat_heads__gqa_block_cached__gqa_block_cached__near_ridge'

def setup_inputs():

    _w = (lambda a: (lambda t: t.to(torch.bfloat16) if t.is_floating_point() else t)(torch.as_tensor(a)))
    def _A_setup():
        B, Sq, D = 8, 144, 576
        Hq, Hkv, Sk, Dh = 32, 16, 1024, 128
        assert Hq % Hkv == 0, (Hq, Hkv)
        return {
            "x": _w((lambda *s: torch.randn(*s, dtype=torch.bfloat16) * 0.8)(B, Sq, D)),
            "k_cache": _w((lambda *s: torch.randn(*s, dtype=torch.bfloat16) * 0.8)(B, Hkv, Sk, Dh)),
            "v_cache": _w((lambda *s: torch.randn(*s, dtype=torch.bfloat16) * 0.05)(B, Hkv, Sk, Dh)),
            "wq": _w((lambda *s: torch.randn(*s, dtype=torch.bfloat16) * 0.8)(D, Hq * Dh) * (D ** -0.5)),
            "wo": _w((lambda *s: torch.randn(*s, dtype=torch.bfloat16) * 0.05)(Hq * Dh, D) * ((Hq * Dh) ** -0.5)),
        }
    _A_in = _A_setup()

    def _B_setup():
        B, Sq, D = 8, 144, 576
        Hq, Hkv, Sk, Dh = 32, 16, 1024, 128
        assert Hq % Hkv == 0, (Hq, Hkv)
        return {
            "x": _w((lambda *s: torch.randn(*s, dtype=torch.bfloat16) * 0.8)(B, Sq, D)),
            "k_cache": _w((lambda *s: torch.randn(*s, dtype=torch.bfloat16) * 0.8)(B, Hkv, Sk, Dh)),
            "v_cache": _w((lambda *s: torch.randn(*s, dtype=torch.bfloat16) * 0.05)(B, Hkv, Sk, Dh)),
            "wq": _w((lambda *s: torch.randn(*s, dtype=torch.bfloat16) * 0.8)(D, Hq * Dh) * (D ** -0.5)),
            "wo": _w((lambda *s: torch.randn(*s, dtype=torch.bfloat16) * 0.05)(Hq * Dh, D) * ((Hq * Dh) ** -0.5)),
        }
    _B_in = _B_setup()

    return {
        "A_x": _A_in["x"],
        "A_k_cache": _A_in["k_cache"],
        "A_v_cache": _A_in["v_cache"],
        "A_wq": _A_in["wq"],
        "A_wo": _A_in["wo"],
        "B_x": _B_in["x"],
        "B_k_cache": _B_in["k_cache"],
        "B_v_cache": _B_in["v_cache"],
        "B_wq": _B_in["wq"],
        "B_wo": _B_in["wo"],
    }

def reference(A_x, A_k_cache, A_v_cache, A_wq, A_wo, B_x, B_k_cache, B_v_cache, B_wq, B_wo):
    def _A_ref(x, k_cache, v_cache, wq, wo):
        B, Sq, D = x.shape
        Hq, Dh = 32, 128
        Hkv = k_cache.shape[1]
        rep = Hq // Hkv
        q = (lambda x, *d: x.permute(*d))((x @ wq).reshape(B, Sq, Hq, Dh), 0, 2, 1, 3)
        k = (lambda x, n, axis: torch.repeat_interleave(x, n, dim=axis))(k_cache, rep, axis=1)
        v = (lambda x, n, axis: torch.repeat_interleave(x, n, dim=axis))(v_cache, rep, axis=1)
        scores = torch.einsum("bhqd,bhkd->bhqk", q, k) * (Dh ** -0.5)
        p = _softmax(scores, axis=-1)
        o = torch.einsum("bhqk,bhkd->bhqd", p, v)
        return (lambda x, *d: x.permute(*d))(o, 0, 2, 1, 3).reshape(B, Sq, Hq * Dh) @ wo

    def _B_ref(x, k_cache, v_cache, wq, wo):
        B, Sq, D = x.shape
        Hq, Dh = 32, 128
        Hkv = k_cache.shape[1]
        rep = Hq // Hkv
        q = (lambda x, *d: x.permute(*d))((x @ wq).reshape(B, Sq, Hq, Dh), 0, 2, 1, 3)
        k = (lambda x, n, axis: torch.repeat_interleave(x, n, dim=axis))(k_cache, rep, axis=1)
        v = (lambda x, n, axis: torch.repeat_interleave(x, n, dim=axis))(v_cache, rep, axis=1)
        scores = torch.einsum("bhqd,bhkd->bhqk", q, k) * (Dh ** -0.5)
        p = _softmax(scores, axis=-1)
        o = torch.einsum("bhqk,bhkd->bhqd", p, v)
        return (lambda x, *d: x.permute(*d))(o, 0, 2, 1, 3).reshape(B, Sq, Hq * Dh) @ wo

    a = _A_ref(A_x, A_k_cache, A_v_cache, A_wq, A_wo)
    b = _B_ref(B_x, B_k_cache, B_v_cache, B_wq, B_wo)
    return torch.concatenate([a, b], axis=-1)
```

```asm
; @launch kernel=attn_kernel grid=(256,1,1) block=(256,1,1) lds=163840
; @launch kernel=reduce_kernel grid=(216,1,1) block=(768,1,1) lds=0
.amdgcn_target "amdgcn-amd-amdhsa--gfx950"
.text
.globl attn_kernel
.p2align 8
.type attn_kernel,@function
attn_kernel:
    s_cmp_ge_u32 s2, 256
    s_cbranch_scc1 K1_END
    s_load_dwordx16 s[40:55], s[0:1], 0
    s_load_dwordx4 s[56:59], s[0:1], 64
    s_load_dwordx2 s[60:61], s[0:1], 96
    v_mov_b32 v100, 0
    v_mov_b32 v101, 0
    v_mov_b32 v102, 0
    v_mov_b32 v103, 0
    v_mov_b32 v104, 0
    s_getpc_b64 s[8:9]
    v_mul_u32_u24 v106, 88, v0
    v_mfma_f32_32x32x16_bf16 v[108:123], v[100:103], v[100:103], 0
    global_load_dword v106, v106, s[8:9] offset:512
    v_lshrrev_b32 v9, 6, v0
    v_and_b32 v0, 63, v0
    v_readfirstlane_b32 s24, v9
    v_lshlrev_b32 v8, 4, v0
    s_and_b32 s25, s24, 1
    s_lshr_b32 s26, s24, 1
    v_mfma_f32_32x32x16_bf16 v[124:139], v[100:103], v[100:103], 0
    s_mul_i32 s29, s24, 4352
    s_mul_i32 s30, s24, 2304
    s_add_u32 s30, s30, 79872
    s_mul_i32 s67, s24, 4224
    v_lshrrev_b32 v9, 5, v0
    v_lshlrev_b32 v9, 17, v9
    v_mfma_f32_32x32x16_bf16 v[140:155], v[100:103], v[100:103], 0
    v_and_b32 v10, 31, v0
    v_lshl_add_u32 v9, v10, 4, v9
    s_lshl_b32 s63, s24, 15
    v_add_u32 v24, s63, v9
    v_add_u32 v25, 7104, v24
    v_add_u32 v26, 14208, v24
    v_add_u32 v27, 21312, v24
    v_mfma_f32_32x32x16_bf16 v[156:171], v[100:103], v[100:103], 0
    s_mul_i32 s63, s24, 18
    v_lshrrev_b32 v9, 3, v0
    v_add_u32 v9, s63, v9
    v_bfe_u32 v10, v9, 2, 2
    v_sub_u32 v10, 0, v10
    v_and_b32 v10, 3, v10
    v_bfe_u32 v11, v9, 1, 1
    v_mfma_f32_32x32x16_bf16 v[172:187], v[100:103], v[100:103], 0
    v_lshl_add_u32 v10, v11, 2, v10
    v_xor_b32 v10, v10, v0
    v_and_b32 v10, 7, v10
    v_mul_u32_u24 v9, 1152, v9
    v_lshl_add_u32 v28, v10, 4, v9
    v_xor_b32 v9, 32, v28
    v_add_u32 v29, 8192, v9
    v_mfma_f32_32x32x16_bf16 v[188:203], v[100:103], v[100:103], 0
    v_add_u32 v38, 82944, v9
    v_add_u32 v39, 91136, v28
    s_add_u32 s63, s63, 16
    v_lshrrev_b32 v9, 5, v0
    v_add_u32 v9, s63, v9
    v_bfe_u32 v10, v9, 2, 2
    v_sub_u32 v10, 0, v10
    v_mfma_f32_32x32x16_bf16 v[204:219], v[100:103], v[100:103], 0
    v_and_b32 v10, 3, v10
    v_bfe_u32 v11, v9, 1, 1
    v_lshl_add_u32 v10, v11, 2, v10
    v_lshrrev_b32 v11, 2, v0
    v_xor_b32 v10, v10, v11
    v_and_b32 v10, 7, v10
    v_mul_u32_u24 v9, 1152, v9
    v_mfma_f32_32x32x16_bf16 v[220:235], v[100:103], v[100:103], 0
    v_lshl_add_u32 v9, v10, 4, v9
    v_and_b32 v10, 3, v0
    v_lshl_add_u32 v9, v10, 2, v9
    v_subrev_u32 v30, 2048, v9
    v_xor_b32 v9, 32, v9
    v_add_u32 v40, 80896, v9
    v_mfma_f32_32x32x16_bf16 v[236:251], v[100:103], v[100:103], 0
    s_and_b32 s63, s2, 7
    s_lshr_b32 s64, s2, 3
    s_lshr_b32 s69, s63, 2
    s_and_b32 s63, s63, 3
    s_lshl_b32 s63, s63, 2
    s_and_b32 s65, s64, 3
    s_add_u32 s63, s63, s65
    v_mfma_f32_32x32x16_bf16 a[0:15], v[100:103], v[100:103], 0
    s_lshr_b32 s64, s64, 2
    v_lshrrev_b32 v31, 2, v0
    v_lshlrev_b32 v31, 13, v31
    v_and_b32 v32, 3, v0
    v_lshl_add_u32 v31, v32, 7, v31
    s_lshl_b32 s65, s64, 2
    s_add_u32 s65, s65, s24
    v_mfma_f32_32x32x16_bf16 a[16:31], v[100:103], v[100:103], 0
    s_lshl_b32 s65, s65, 14
    v_add_u32 v31, s65, v31
    v_mov_b32 v34, 0x40000000
    v_cmp_gt_u32 vcc, 8, v0
    v_mul_u32_u24 v32, 1152, v0
    v_lshlrev_b32 v33, 7, v0
    v_cndmask_b32 v31, v34, v31, vcc
    v_mfma_f32_32x32x16_bf16 a[32:47], v[100:103], v[100:103], 0
    v_cndmask_b32 v33, v34, v33, vcc
    s_and_b32 s65, s63, 3
    s_lshl_b32 s65, s65, 2
    s_add_u32 s65, s65, s24
    s_mul_i32 s65, s65, 10368
    v_add_u32 v32, s65, v32
    v_cmp_gt_u32 vcc, 9, v0
    v_mfma_f32_32x32x16_bf16 a[48:63], v[100:103], v[100:103], 0
    s_lshl_b32 s65, s24, 10
    v_add_u32 v33, s65, v33
    v_cndmask_b32 v32, v34, v32, vcc
    s_waitcnt lgkmcnt(0)
    s_cmp_eq_u32 s69, 0
    s_cselect_b32 s4, s40, s50
    v_mfma_f32_32x32x16_bf16 a[64:79], v[100:103], v[100:103], 0
    s_cselect_b32 s5, s41, s51
    s_cselect_b32 s8, s46, s56
    s_cselect_b32 s9, s47, s57
    s_cselect_b32 s12, s42, s52
    s_cselect_b32 s13, s43, s53
    s_cselect_b32 s16, s44, s54
    s_cselect_b32 s17, s45, s55
    v_mfma_f32_32x32x16_bf16 a[80:95], v[100:103], v[100:103], 0
    s_cselect_b32 s40, s48, s58
    s_cselect_b32 s41, s49, s59
    s_mul_i32 s65, s64, 165888
    s_add_u32 s4, s4, s65
    s_addc_u32 s5, s5, 0
    s_mov_b32 s6, 165888
    s_mov_b32 s7, 0x00020000
    v_mfma_f32_32x32x16_bf16 a[96:111], v[100:103], v[100:103], 0
    s_lshl_b32 s65, s63, 9
    s_add_u32 s8, s8, s65
    s_addc_u32 s9, s9, 0
    s_sub_u32 s10, 4718592, s65
    s_mov_b32 s11, 0x00020000
    s_mov_b32 s31, 0
    s_mov_b32 s32, 0
    v_mfma_f32_32x32x16_bf16 a[112:127], v[100:103], v[100:103], 0
    s_mov_b32 s47, 0
    s_mov_b32 s50, 0
    s_mov_b32 s51, 0
    buffer_load_dword v106, v31, s[8:11], s47 offen
    buffer_load_dword v106, v32, s[4:7], s50 offen
    s_add_u32 s47, s47, 524288
    s_add_u32 s50, s50, 128
    v_mfma_f32_32x32x16_bf16 a[128:143], v[100:103], v[100:103], 0
    s_mov_b32 s27, 0
    s_add_u32 m0, s27, s29
    s_nop 0
    buffer_load_dwordx4 v24, s[8:11], s31 offen offset:0 lds
    buffer_load_dwordx4 v25, s[8:11], s31 offen offset:1088 lds
    buffer_load_dwordx4 v26, s[8:11], s31 offen offset:2176 lds
    buffer_load_dwordx4 v27, s[8:11], s31 offen offset:3264 lds
    s_add_u32 m0, 0, s30
    s_nop 0
    buffer_load_dwordx4 v28, s[4:7], s32 offen offset:0 lds
    buffer_load_dwordx4 v29, s[4:7], s32 offen offset:1024 lds
    buffer_load_dword v30, s[4:7], s32 offen offset:2048 lds
    v_mfma_f32_32x32x16_bf16 a[144:159], v[100:103], v[100:103], 0
    s_add_u32 m0, 9216, s30
    s_nop 0
    buffer_load_dwordx4 v38, s[4:7], s32 offen offset:0 lds
    buffer_load_dwordx4 v39, s[4:7], s32 offen offset:1024 lds
    buffer_load_dword v40, s[4:7], s32 offen offset:2048 lds
    s_add_u32 s31, s31, 262144
    s_add_u32 s32, s32, 128
    buffer_load_dword v106, v31, s[8:11], s47 offen
    buffer_load_dword v106, v32, s[4:7], s50 offen
    s_add_u32 s47, s47, 524288
    s_add_u32 s50, s50, 128
    buffer_load_dword v106, v31, s[8:11], s47 offen
    buffer_load_dword v106, v32, s[4:7], s50 offen
    s_add_u32 s47, s47, 524288
    s_add_u32 s50, s50, 128
    v_lshrrev_b32 v35, 3, v0
    v_lshlrev_b32 v35, 19, v35
    v_bfe_u32 v36, v0, 2, 1
    v_lshl_add_u32 v35, v36, 13, v35
    v_and_b32 v36, 3, v0
    v_lshl_add_u32 v35, v36, 7, v35
    s_lshl_b32 s65, s64, 2
    s_add_u32 s65, s65, s24
    s_lshl_b32 s65, s65, 14
    v_add_u32 v35, s65, v35
    v_cmp_gt_u32 vcc, 16, v0
    v_lshrrev_b32 v37, 2, v0
    v_mul_u32_u24 v37, 1152, v37
    v_cndmask_b32 v35, v34, v35, vcc
    v_cmp_gt_u32 vcc, 2, v36
    v_lshl_add_u32 v36, v36, 7, v37
    s_and_b32 s65, s63, 3
    s_lshl_b32 s65, s65, 2
    s_add_u32 s65, s65, s24
    s_mul_i32 s65, s65, 10368
    v_add_u32 v36, s65, v36
    v_cndmask_b32 v36, v34, v36, vcc
    v_cmp_gt_u32 vcc, 36, v0
    v_lshlrev_b32 v37, 7, v0
    s_lshl_b32 s65, s24, 12
    v_cndmask_b32 v36, v34, v36, vcc
    v_add_u32 v37, s65, v37
    v_cmp_gt_u32 vcc, 32, v0
    s_mov_b32 s52, 21
    s_nop 0
    v_cndmask_b32 v37, v34, v37, vcc
    s_mul_i32 s65, s63, 294912
    s_add_u32 s56, s40, s65
    s_addc_u32 s57, s41, 0
    s_mov_b32 s58, 294912
    s_mov_b32 s59, 0x00020000
    s_lshl_b32 s65, s63, 3
    s_add_u32 s65, s65, s64
    s_lshl_b32 s65, s65, 2
    s_add_u32 s65, s65, s24
    s_mul_i32 s65, s65, 9216
    s_add_u32 s40, s40, s65
    s_addc_u32 s41, s41, 0
    s_mov_b32 s42, 9216
    s_mov_b32 s43, 0x00020000
    s_mov_b32 s44, 0
    s_mov_b32 s45, 8192
    s_mov_b32 s46, 8192
    v_lshlrev_b32 v105, 7, v0
    s_lshr_b32 s48, s2, 4
    s_add_u32 s48, s48, s2
    s_and_b32 s48, s48, 0
    s_lshl_b32 s48, s48, 14
    s_lshl_b32 s65, s64, 4
    s_add_u32 s65, s65, s63
    s_lshl_b32 s65, s65, 18
    s_add_u32 s12, s12, s65
    s_addc_u32 s13, s13, 0
    s_mov_b32 s14, 262144
    s_mov_b32 s15, 0x00020000
    s_add_u32 s16, s16, s65
    s_addc_u32 s17, s17, 0
    s_mov_b32 s18, 262144
    s_mov_b32 s19, 0x00020000
    s_lshl_b32 s65, s69, 3
    s_add_u32 s65, s65, s64
    s_lshl_b32 s65, s65, 4
    s_add_u32 s65, s65, s63
    s_mul_i32 s65, s65, 165888
    s_lshl_b32 s66, s24, 12
    s_add_u32 s65, s65, s66
    s_add_u32 s65, s65, 67108864
    s_add_u32 s20, s60, s65
    s_addc_u32 s21, s61, 0
    s_sub_u32 s22, 165888, s66
    s_mov_b32 s23, 0x00020000
    s_mov_b32 s62, 1
    s_mov_b32 s68, 0x3e0293ee
    v_lshrrev_b32 v9, 4, v0
    v_lshlrev_b32 v9, 8, v9
    v_and_b32 v10, 15, v0
    v_lshl_add_u32 v9, v10, 4, v9
    s_lshl_b32 s63, s24, 12
    v_add_u32 v7, s63, v9
    v_bfe_u32 v9, v0, 4, 1
    v_bfe_u32 v10, v0, 2, 2
    v_lshl_add_u32 v9, v9, 3, v10
    v_mul_u32_u24 v9, 1088, v9
    v_lshrrev_b32 v10, 5, v0
    v_lshl_add_u32 v9, v10, 9, v9
    v_and_b32 v10, 3, v0
    v_lshl_add_u32 v9, v10, 4, v9
    s_lshl_b32 s63, s26, 8
    s_lshl_b32 s64, s25, 7
    s_add_u32 s65, s63, s64
    s_xor_b32 s66, s65, 128
    v_add_u32 v16, s65, v9
    v_add_u32 v17, s66, v9
    v_and_b32 v9, 15, v0
    v_bfe_u32 v10, v0, 2, 2
    v_sub_u32 v10, 0, v10
    v_lshrrev_b32 v11, 4, v0
    v_xor_b32 v10, v10, v11
    v_and_b32 v10, 3, v10
    v_bfe_u32 v11, v0, 1, 1
    v_lshl_add_u32 v10, v11, 2, v10
    v_lshlrev_b32 v9, 7, v9
    v_lshl_add_u32 v9, v10, 4, v9
    v_add_u32 v19, 79872, v9
    s_lshl_b32 s63, s25, 13
    v_add_u32 v18, s63, v19
    v_and_b32 v9, 15, v0
    v_bfe_u32 v10, v0, 4, 2
    v_mul_u32_u24 v11, 1056, v9
    v_lshl_add_u32 v11, v10, 4, v11
    v_add_u32 v11, 101376, v11
    s_lshl_b32 s63, s25, 9
    s_xor_b32 s64, s63, 512
    s_lshl_b32 s65, s25, 7
    s_xor_b32 s66, s65, 128
    v_add_u32 v12, s63, v11
    v_add_u32 v1, s65, v12
    v_add_u32 v2, s66, v12
    v_add_u32 v12, s64, v11
    v_add_u32 v3, s65, v12
    v_add_u32 v4, s66, v12
    v_bfe_u32 v9, v0, 2, 4
    v_and_b32 v10, 3, v0
    v_mul_u32_u24 v11, 1056, v9
    v_lshl_add_u32 v11, v10, 3, v11
    v_add_u32 v5, s63, v11
    v_add_u32 v6, s64, v11
    s_mov_b32 s35, s67
    s_add_u32 s34, s67, 67584
    s_xor_b32 s36, s34, s35
    s_mov_b32 s38, 16384
    s_mov_b32 s39, 32768
    s_xor_b32 s49, s38, s48
    s_xor_b32 s69, s39, s48
    v_mov_b32 v252, 0x3f803f80
    v_mov_b32 v253, 0x3f803f80
    v_mov_b32 v254, 0x3f803f80
    v_mov_b32 v255, 0x3f803f80
    s_mov_b32 s28, 0
    v_add_u32 v20, s28, v16
    v_add_u32 v21, s28, v17
    v_add_u32 v22, s51, v18
    v_add_u32 v23, s51, v19
    s_lshl_b32 s63, s24, 11
    s_add_u32 s63, s63, 131072
    s_xor_b32 s64, s63, 2048
    v_add_u32 v13, s63, v8
    v_add_u32 v14, s64, v8
    v_bfe_u32 v9, v0, 4, 2
    v_lshlrev_b32 v9, 4, v9
    s_lshl_b32 s65, s25, 7
    s_add_u32 s65, s65, 135168
    s_xor_b32 s66, s65, 128
    v_add_u32 v10, s66, v9
    v_add_u32 v9, s65, v9
    s_mov_b32 s27, 26624
    s_add_u32 m0, s27, s29
    s_nop 0
    buffer_load_dwordx4 v24, s[8:11], s31 offen offset:0 lds
    buffer_load_dwordx4 v25, s[8:11], s31 offen offset:1088 lds
    buffer_load_dwordx4 v26, s[8:11], s31 offen offset:2176 lds
    buffer_load_dwordx4 v27, s[8:11], s31 offen offset:3264 lds
    s_add_u32 m0, 18432, s30
    s_nop 0
    buffer_load_dwordx4 v28, s[4:7], s32 offen offset:0 lds
    buffer_load_dwordx4 v29, s[4:7], s32 offen offset:1024 lds
    buffer_load_dword v30, s[4:7], s32 offen offset:2048 lds
    s_add_u32 s31, s31, 262144
    s_waitcnt vmcnt(11)
    s_barrier
    ds_read_b128 a[224:227], v22 offset:0
    ds_read_b128 a[228:231], v22 offset:2048
    ds_read_b128 a[232:235], v22 offset:4096
    ds_read_b128 a[236:239], v22 offset:6144
    ds_read_b128 a[240:243], v23 offset:16384
    ds_read_b64_tr_b16 a[160:161], v20 offset:0
    ds_read_b64_tr_b16 a[162:163], v20 offset:4352
    ds_read_b64_tr_b16 a[164:165], v20 offset:8
    ds_read_b64_tr_b16 a[166:167], v20 offset:4360
    ds_read_b64_tr_b16 a[168:169], v20 offset:64
    ds_read_b64_tr_b16 a[170:171], v20 offset:4416
    ds_read_b64_tr_b16 a[172:173], v20 offset:72
    ds_read_b64_tr_b16 a[174:175], v20 offset:4424
    ds_read_b64_tr_b16 a[176:177], v21 offset:0
    ds_read_b64_tr_b16 a[178:179], v21 offset:4352
    ds_read_b64_tr_b16 a[180:181], v21 offset:8
    ds_read_b64_tr_b16 a[182:183], v21 offset:4360
    ds_read_b64_tr_b16 a[184:185], v21 offset:64
    ds_read_b64_tr_b16 a[186:187], v21 offset:4416
    ds_read_b64_tr_b16 a[188:189], v21 offset:72
    ds_read_b64_tr_b16 a[190:191], v21 offset:4424
    s_mov_b32 s27, 53248
    s_add_u32 m0, s27, s29
    s_nop 0
    buffer_load_dwordx4 v24, s[8:11], s31 offen offset:0 lds
    buffer_load_dwordx4 v25, s[8:11], s31 offen offset:1088 lds
    buffer_load_dwordx4 v26, s[8:11], s31 offen offset:2176 lds
    buffer_load_dwordx4 v27, s[8:11], s31 offen offset:3264 lds
    s_add_u32 m0, 27648, s30
    s_nop 0
    buffer_load_dwordx4 v38, s[4:7], s32 offen offset:0 lds
    buffer_load_dwordx4 v39, s[4:7], s32 offen offset:1024 lds
    buffer_load_dword v40, s[4:7], s32 offen offset:2048 lds
    s_add_u32 s31, s31, 262144
    s_add_u32 s32, s32, 128
    s_mov_b32 s27, s28
    s_add_u32 s28, s28, 26624
    s_cmp_eq_u32 s28, 79872
    s_cselect_b32 s28, 0, s28
    v_add_u32 v20, s28, v16
    v_add_u32 v21, s28, v17
    v_xor_b32 v22, 64, v22
    v_xor_b32 v23, 64, v23
    s_mov_b32 s55, 36864
    s_mov_b32 s33, 7
    s_waitcnt vmcnt(7) lgkmcnt(0)
    s_barrier
K1_QLOOP:
    v_mfma_f32_16x16x32_bf16 v[108:111], a[160:163], a[224:227], v[108:111]
    s_add_u32 s51, s51, 18432
    ds_read_b128 v[80:83], v22 offset:0
    v_mfma_f32_16x16x32_bf16 v[140:143], a[160:163], a[228:231], v[140:143]
    ds_read_b128 v[84:87], v22 offset:2048
    v_mfma_f32_16x16x32_bf16 v[172:175], a[160:163], a[232:235], v[172:175]
    s_add_u32 m0, s27, s29
    ds_read_b128 v[88:91], v22 offset:4096
    v_mfma_f32_16x16x32_bf16 v[204:207], a[160:163], a[236:239], v[204:207]
    s_mov_b32 s27, s28
    buffer_load_dwordx4 v24, s[8:11], s31 offen offset:0 lds
    v_mfma_f32_16x16x32_bf16 v[236:239], a[160:163], a[240:243], v[236:239]
    s_add_u32 s28, s28, 26624
    ds_read_b128 v[92:95], v22 offset:6144
    v_mfma_f32_16x16x32_bf16 v[112:115], a[164:167], a[224:227], v[112:115]
    s_cmp_eq_u32 s28, 79872
    ds_read_b128 v[96:99], v23 offset:16384
    v_mfma_f32_16x16x32_bf16 v[144:147], a[164:167], a[228:231], v[144:147]
    s_cselect_b32 s28, 0, s28
    buffer_load_dwordx4 v25, s[8:11], s31 offen offset:1088 lds
    v_mfma_f32_16x16x32_bf16 v[176:179], a[164:167], a[232:235], v[176:179]
    s_cmp_eq_u32 s51, 55296
    ds_read_b64_tr_b16 a[192:193], v20 offset:0
    v_mfma_f32_16x16x32_bf16 v[208:211], a[164:167], a[236:239], v[208:211]
    s_cselect_b32 s51, 0, s51
    ds_read_b64_tr_b16 a[194:195], v20 offset:4352
    v_mfma_f32_16x16x32_bf16 v[240:243], a[164:167], a[240:243], v[240:243]
    buffer_load_dwordx4 v26, s[8:11], s31 offen offset:2176 lds
    v_mfma_f32_16x16x32_bf16 v[116:119], a[168:171], a[224:227], v[116:119]
    ds_read_b64_tr_b16 a[196:197], v20 offset:8
    v_add_u32 v22, s51, v18
    v_mfma_f32_16x16x32_bf16 v[148:151], a[168:171], a[228:231], v[148:151]
    ds_read_b64_tr_b16 a[198:199], v20 offset:4360
    v_add_u32 v23, s51, v19
    v_mfma_f32_16x16x32_bf16 v[180:183], a[168:171], a[232:235], v[180:183]
    ds_read_b64_tr_b16 a[200:201], v20 offset:64
    v_mfma_f32_16x16x32_bf16 v[212:215], a[168:171], a[236:239], v[212:215]
    buffer_load_dwordx4 v27, s[8:11], s31 offen offset:3264 lds
    v_mfma_f32_16x16x32_bf16 v[244:247], a[168:171], a[240:243], v[244:247]
    s_add_u32 s31, s31, 262144
    ds_read_b64_tr_b16 a[202:203], v20 offset:4416
    v_mfma_f32_16x16x32_bf16 v[120:123], a[172:175], a[224:227], v[120:123]
    s_add_u32 m0, s55, s30
    ds_read_b64_tr_b16 a[204:205], v20 offset:72
    v_mfma_f32_16x16x32_bf16 v[152:155], a[172:175], a[228:231], v[152:155]
    s_add_u32 s55, s55, 9216
    buffer_load_dwordx4 v28, s[4:7], s32 offen offset:0 lds
    v_mfma_f32_16x16x32_bf16 v[184:187], a[172:175], a[232:235], v[184:187]
    s_cmp_eq_u32 s55, 55296
    ds_read_b64_tr_b16 a[206:207], v20 offset:4424
    v_mfma_f32_16x16x32_bf16 v[216:219], a[172:175], a[236:239], v[216:219]
    s_cselect_b32 s55, 0, s55
    ds_read_b64_tr_b16 a[208:209], v21 offset:0
    v_add_u32 v20, s28, v16
    v_mfma_f32_16x16x32_bf16 v[248:251], a[172:175], a[240:243], v[248:251]
    buffer_load_dwordx4 v29, s[4:7], s32 offen offset:1024 lds
    v_mfma_f32_16x16x32_bf16 v[124:127], a[176:179], a[224:227], v[124:127]
    ds_read_b64_tr_b16 a[210:211], v21 offset:4352
    v_mfma_f32_16x16x32_bf16 v[156:159], a[176:179], a[228:231], v[156:159]
    ds_read_b64_tr_b16 a[212:213], v21 offset:8
    v_mfma_f32_16x16x32_bf16 v[188:191], a[176:179], a[232:235], v[188:191]
    ds_read_b64_tr_b16 a[214:215], v21 offset:4360
    v_mfma_f32_16x16x32_bf16 v[220:223], a[176:179], a[236:239], v[220:223]
    buffer_load_dword v30, s[4:7], s32 offen offset:2048 lds
    v_mfma_f32_16x16x32_bf16 v[128:131], a[180:183], a[224:227], v[128:131]
    s_bitcmp1_b32 s52, 0
    s_cselect_b32 s53, s47, 0x40000000
    ds_read_b64_tr_b16 a[216:217], v21 offset:64
    v_mfma_f32_16x16x32_bf16 v[160:163], a[180:183], a[228:231], v[160:163]
    s_cselect_b32 s54, s50, 0x40000000
    ds_read_b64_tr_b16 a[218:219], v21 offset:4416
    v_mfma_f32_16x16x32_bf16 v[192:195], a[180:183], a[232:235], v[192:195]
    s_add_u32 s47, s47, 524288
    buffer_load_dword v106, v35, s[8:11], s53 offen
    v_mfma_f32_16x16x32_bf16 v[224:227], a[180:183], a[236:239], v[224:227]
    s_add_u32 s50, s50, 128
    ds_read_b64_tr_b16 a[220:221], v21 offset:72
    v_mfma_f32_16x16x32_bf16 v[132:135], a[184:187], a[224:227], v[132:135]
    s_lshr_b32 s52, s52, 1
    ds_read_b64_tr_b16 a[222:223], v21 offset:4424
    v_mfma_f32_16x16x32_bf16 v[164:167], a[184:187], a[228:231], v[164:167]
    buffer_load_dword v106, v36, s[4:7], s54 offen
    v_mfma_f32_16x16x32_bf16 v[196:199], a[184:187], a[232:235], v[196:199]
    v_add_u32 v21, s28, v17
    v_mfma_f32_16x16x32_bf16 v[228:231], a[184:187], a[236:239], v[228:231]
    v_mfma_f32_16x16x32_bf16 v[136:139], a[188:191], a[224:227], v[136:139]
    v_mfma_f32_16x16x32_bf16 v[168:171], a[188:191], a[228:231], v[168:171]
    v_mfma_f32_16x16x32_bf16 v[200:203], a[188:191], a[232:235], v[200:203]
    s_waitcnt vmcnt(9) lgkmcnt(0)
    v_mfma_f32_16x16x32_bf16 v[232:235], a[188:191], a[236:239], v[232:235]
    s_barrier
    v_mfma_f32_16x16x32_bf16 v[108:111], a[192:195], v[80:83], v[108:111]
    ds_read_b128 a[224:227], v22 offset:0
    v_mfma_f32_16x16x32_bf16 v[140:143], a[192:195], v[84:87], v[140:143]
    ds_read_b128 a[228:231], v22 offset:2048
    v_mfma_f32_16x16x32_bf16 v[172:175], a[192:195], v[88:91], v[172:175]
    s_add_u32 m0, s27, s29
    ds_read_b128 a[232:235], v22 offset:4096
    v_mfma_f32_16x16x32_bf16 v[204:207], a[192:195], v[92:95], v[204:207]
    s_mov_b32 s27, s28
    buffer_load_dwordx4 v24, s[8:11], s31 offen offset:0 lds
    v_mfma_f32_16x16x32_bf16 v[236:239], a[192:195], v[96:99], v[236:239]
    s_add_u32 s28, s28, 26624
    ds_read_b128 a[236:239], v22 offset:6144
    v_mfma_f32_16x16x32_bf16 v[112:115], a[196:199], v[80:83], v[112:115]
    s_cmp_eq_u32 s28, 79872
    ds_read_b128 a[240:243], v23 offset:16384
    v_mfma_f32_16x16x32_bf16 v[144:147], a[196:199], v[84:87], v[144:147]
    s_cselect_b32 s28, 0, s28
    ds_read_b64_tr_b16 a[160:161], v20 offset:0
    v_mfma_f32_16x16x32_bf16 v[176:179], a[196:199], v[88:91], v[176:179]
    buffer_load_dwordx4 v25, s[8:11], s31 offen offset:1088 lds
    v_mfma_f32_16x16x32_bf16 v[208:211], a[196:199], v[92:95], v[208:211]
    ds_read_b64_tr_b16 a[162:163], v20 offset:4352
    v_xor_b32 v22, 64, v22
    v_mfma_f32_16x16x32_bf16 v[240:243], a[196:199], v[96:99], v[240:243]
    ds_read_b64_tr_b16 a[164:165], v20 offset:8
    v_xor_b32 v23, 64, v23
    v_mfma_f32_16x16x32_bf16 v[116:119], a[200:203], v[80:83], v[116:119]
    ds_read_b64_tr_b16 a[166:167], v20 offset:4360
    v_mfma_f32_16x16x32_bf16 v[148:151], a[200:203], v[84:87], v[148:151]
    buffer_load_dwordx4 v26, s[8:11], s31 offen offset:2176 lds
    v_mfma_f32_16x16x32_bf16 v[180:183], a[200:203], v[88:91], v[180:183]
    ds_read_b64_tr_b16 a[168:169], v20 offset:64
    v_mfma_f32_16x16x32_bf16 v[212:215], a[200:203], v[92:95], v[212:215]
    ds_read_b64_tr_b16 a[170:171], v20 offset:4416
    v_mfma_f32_16x16x32_bf16 v[244:247], a[200:203], v[96:99], v[244:247]
    ds_read_b64_tr_b16 a[172:173], v20 offset:72
    v_mfma_f32_16x16x32_bf16 v[120:123], a[204:207], v[80:83], v[120:123]
    buffer_load_dwordx4 v27, s[8:11], s31 offen offset:3264 lds
    v_mfma_f32_16x16x32_bf16 v[152:155], a[204:207], v[84:87], v[152:155]
    s_add_u32 s31, s31, 262144
    ds_read_b64_tr_b16 a[174:175], v20 offset:4424
    v_mfma_f32_16x16x32_bf16 v[184:187], a[204:207], v[88:91], v[184:187]
    ds_read_b64_tr_b16 a[176:177], v21 offset:0
    v_add_u32 v20, s28, v16
    v_mfma_f32_16x16x32_bf16 v[216:219], a[204:207], v[92:95], v[216:219]
    s_add_u32 m0, s55, s30
    ds_read_b64_tr_b16 a[178:179], v21 offset:4352
    v_mfma_f32_16x16x32_bf16 v[248:251], a[204:207], v[96:99], v[248:251]
    s_add_u32 s55, s55, 9216
    buffer_load_dwordx4 v38, s[4:7], s32 offen offset:0 lds
    v_mfma_f32_16x16x32_bf16 v[124:127], a[208:211], v[80:83], v[124:127]
    s_cmp_eq_u32 s55, 55296
    ds_read_b64_tr_b16 a[180:181], v21 offset:8
    v_mfma_f32_16x16x32_bf16 v[156:159], a[208:211], v[84:87], v[156:159]
    s_cselect_b32 s55, 0, s55
    ds_read_b64_tr_b16 a[182:183], v21 offset:4360
    v_mfma_f32_16x16x32_bf16 v[188:191], a[208:211], v[88:91], v[188:191]
    ds_read_b64_tr_b16 a[184:185], v21 offset:64
    v_mfma_f32_16x16x32_bf16 v[220:223], a[208:211], v[92:95], v[220:223]
    buffer_load_dwordx4 v39, s[4:7], s32 offen offset:1024 lds
    v_mfma_f32_16x16x32_bf16 v[128:131], a[212:215], v[80:83], v[128:131]
    ds_read_b64_tr_b16 a[186:187], v21 offset:4416
    v_mfma_f32_16x16x32_bf16 v[160:163], a[212:215], v[84:87], v[160:163]
    ds_read_b64_tr_b16 a[188:189], v21 offset:72
    v_mfma_f32_16x16x32_bf16 v[192:195], a[212:215], v[88:91], v[192:195]
    ds_read_b64_tr_b16 a[190:191], v21 offset:4424
    v_mfma_f32_16x16x32_bf16 v[224:227], a[212:215], v[92:95], v[224:227]
    buffer_load_dword v40, s[4:7], s32 offen offset:2048 lds
    v_mfma_f32_16x16x32_bf16 v[132:135], a[216:219], v[80:83], v[132:135]
    s_add_u32 s32, s32, 128
    v_add_u32 v21, s28, v17
    v_mfma_f32_16x16x32_bf16 v[164:167], a[216:219], v[84:87], v[164:167]
    v_mfma_f32_16x16x32_bf16 v[196:199], a[216:219], v[88:91], v[196:199]
    v_mfma_f32_16x16x32_bf16 v[228:231], a[216:219], v[92:95], v[228:231]
    v_mfma_f32_16x16x32_bf16 v[136:139], a[220:223], v[80:83], v[136:139]
    v_mfma_f32_16x16x32_bf16 v[168:171], a[220:223], v[84:87], v[168:171]
    s_sub_u32 s33, s33, 1
    v_mfma_f32_16x16x32_bf16 v[200:203], a[220:223], v[88:91], v[200:203]
    s_cmp_lg_u32 s33, 0
    s_waitcnt vmcnt(9) lgkmcnt(0)
    v_mfma_f32_16x16x32_bf16 v[232:235], a[220:223], v[92:95], v[232:235]
    s_barrier
    s_cbranch_scc1 K1_QLOOP
    v_mfma_f32_16x16x32_bf16 v[108:111], a[160:163], a[224:227], v[108:111]
    s_add_u32 s51, s51, 18432
    ds_read_b128 v[80:83], v22 offset:0
    v_mfma_f32_16x16x32_bf16 v[140:143], a[160:163], a[228:231], v[140:143]
    ds_read_b128 v[84:87], v22 offset:2048
    v_mfma_f32_16x16x32_bf16 v[172:175], a[160:163], a[232:235], v[172:175]
    s_add_u32 m0, s27, s29
    ds_read_b128 v[88:91], v22 offset:4096
    v_mfma_f32_16x16x32_bf16 v[204:207], a[160:163], a[236:239], v[204:207]
    s_mov_b32 s27, s28
    buffer_load_dwordx4 v24, s[8:11], s31 offen offset:0 lds
    v_mfma_f32_16x16x32_bf16 v[236:239], a[160:163], a[240:243], v[236:239]
    s_add_u32 s28, s28, 26624
    ds_read_b128 v[92:95], v22 offset:6144
    v_mfma_f32_16x16x32_bf16 v[112:115], a[164:167], a[224:227], v[112:115]
    s_cmp_eq_u32 s28, 79872
    ds_read_b128 v[96:99], v23 offset:16384
    v_mfma_f32_16x16x32_bf16 v[144:147], a[164:167], a[228:231], v[144:147]
    s_cselect_b32 s28, 0, s28
    ds_read_b64_tr_b16 a[192:193], v20 offset:0
    v_mfma_f32_16x16x32_bf16 v[176:179], a[164:167], a[232:235], v[176:179]
    s_cmp_eq_u32 s51, 55296
    buffer_load_dwordx4 v25, s[8:11], s31 offen offset:1088 lds
    v_mfma_f32_16x16x32_bf16 v[208:211], a[164:167], a[236:239], v[208:211]
    s_cselect_b32 s51, 0, s51
    ds_read_b64_tr_b16 a[194:195], v20 offset:4352
    v_mfma_f32_16x16x32_bf16 v[240:243], a[164:167], a[240:243], v[240:243]
    ds_read_b64_tr_b16 a[196:197], v20 offset:8
    v_add_u32 v22, s51, v18
    v_mfma_f32_16x16x32_bf16 v[116:119], a[168:171], a[224:227], v[116:119]
    buffer_load_dwordx4 v26, s[8:11], s31 offen offset:2176 lds
    v_mfma_f32_16x16x32_bf16 v[148:151], a[168:171], a[228:231], v[148:151]
    ds_read_b64_tr_b16 a[198:199], v20 offset:4360
    v_add_u32 v23, s51, v19
    v_mfma_f32_16x16x32_bf16 v[180:183], a[168:171], a[232:235], v[180:183]
    ds_read_b64_tr_b16 a[200:201], v20 offset:64
    v_mfma_f32_16x16x32_bf16 v[212:215], a[168:171], a[236:239], v[212:215]
    ds_read_b64_tr_b16 a[202:203], v20 offset:4416
    v_mfma_f32_16x16x32_bf16 v[244:247], a[168:171], a[240:243], v[244:247]
    buffer_load_dwordx4 v27, s[8:11], s31 offen offset:3264 lds
    v_mfma_f32_16x16x32_bf16 v[120:123], a[172:175], a[224:227], v[120:123]
    ds_read_b64_tr_b16 a[204:205], v20 offset:72
    v_mfma_f32_16x16x32_bf16 v[152:155], a[172:175], a[228:231], v[152:155]
    s_xor_b32 s63, s48, 0
    ds_read_b64_tr_b16 a[206:207], v20 offset:4424
    v_mfma_f32_16x16x32_bf16 v[184:187], a[172:175], a[232:235], v[184:187]
    s_add_u32 m0, s67, 135168
    ds_read_b64_tr_b16 a[208:209], v21 offset:0
    v_add_u32 v20, s28, v16
    v_mfma_f32_16x16x32_bf16 v[216:219], a[172:175], a[236:239], v[216:219]
    buffer_load_dwordx4 v7, s[12:15], s63 offen offset:0 nt lds
    v_mfma_f32_16x16x32_bf16 v[248:251], a[172:175], a[240:243], v[248:251]
    ds_read_b64_tr_b16 a[210:211], v21 offset:4352
    v_mfma_f32_16x16x32_bf16 v[124:127], a[176:179], a[224:227], v[124:127]
    s_add_u32 m0, s67, 135200
    ds_read_b64_tr_b16 a[212:213], v21 offset:8
    v_mfma_f32_16x16x32_bf16 v[156:159], a[176:179], a[228:231], v[156:159]
    buffer_load_dwordx4 v7, s[12:15], s63 offen offset:1024 nt lds
    v_mfma_f32_16x16x32_bf16 v[188:191], a[176:179], a[232:235], v[188:191]
    ds_read_b64_tr_b16 a[214:215], v21 offset:4360
    v_mfma_f32_16x16x32_bf16 v[220:223], a[176:179], a[236:239], v[220:223]
    ds_read_b64_tr_b16 a[216:217], v21 offset:64
    v_mfma_f32_16x16x32_bf16 v[128:131], a[180:183], a[224:227], v[128:131]
    s_add_u32 m0, s67, 135232
    ds_read_b64_tr_b16 a[218:219], v21 offset:4416
    v_mfma_f32_16x16x32_bf16 v[160:163], a[180:183], a[228:231], v[160:163]
    buffer_load_dwordx4 v7, s[12:15], s63 offen offset:2048 nt lds
    v_mfma_f32_16x16x32_bf16 v[192:195], a[180:183], a[232:235], v[192:195]
    ds_read_b64_tr_b16 a[220:221], v21 offset:72
    v_mfma_f32_16x16x32_bf16 v[224:227], a[180:183], a[236:239], v[224:227]
    s_add_u32 m0, s67, 135264
    ds_read_b64_tr_b16 a[222:223], v21 offset:4424
    v_mfma_f32_16x16x32_bf16 v[132:135], a[184:187], a[224:227], v[132:135]
    buffer_load_dwordx4 v7, s[12:15], s63 offen offset:3072 nt lds
    v_mfma_f32_16x16x32_bf16 v[164:167], a[184:187], a[228:231], v[164:167]
    v_add_u32 v21, s28, v17
    v_mfma_f32_16x16x32_bf16 v[196:199], a[184:187], a[232:235], v[196:199]
    v_mfma_f32_16x16x32_bf16 v[228:231], a[184:187], a[236:239], v[228:231]
    v_mfma_f32_16x16x32_bf16 v[136:139], a[188:191], a[224:227], v[136:139]
    v_mfma_f32_16x16x32_bf16 v[168:171], a[188:191], a[228:231], v[168:171]
    v_mfma_f32_16x16x32_bf16 v[200:203], a[188:191], a[232:235], v[200:203]
    s_waitcnt vmcnt(8) lgkmcnt(0)
    v_mfma_f32_16x16x32_bf16 v[232:235], a[188:191], a[236:239], v[232:235]
    s_barrier
    v_mfma_f32_16x16x32_bf16 v[108:111], a[192:195], v[80:83], v[108:111]
    s_mov_b32 s27, s28
    ds_read_b128 a[224:227], v22 offset:0
    v_mfma_f32_16x16x32_bf16 v[140:143], a[192:195], v[84:87], v[140:143]
    s_add_u32 s28, s28, 26624
    ds_read_b128 a[228:231], v22 offset:2048
    v_mfma_f32_16x16x32_bf16 v[172:175], a[192:195], v[88:91], v[172:175]
    s_cmp_eq_u32 s28, 79872
    ds_read_b128 a[232:235], v22 offset:4096
    v_mfma_f32_16x16x32_bf16 v[204:207], a[192:195], v[92:95], v[204:207]
    s_cselect_b32 s28, 0, s28
    ds_read_b128 a[236:239], v22 offset:6144
    v_mfma_f32_16x16x32_bf16 v[236:239], a[192:195], v[96:99], v[236:239]
    s_xor_b32 s63, s48, 16384
    ds_read_b128 a[240:243], v23 offset:16384
    v_xor_b32 v22, 64, v22
    v_mfma_f32_16x16x32_bf16 v[112:115], a[196:199], v[80:83], v[112:115]
    s_add_u32 m0, s67, 0
    ds_read_b64_tr_b16 a[160:161], v20 offset:0
    v_xor_b32 v23, 64, v23
    v_mfma_f32_16x16x32_bf16 v[144:147], a[196:199], v[84:87], v[144:147]
    buffer_load_dwordx4 v7, s[12:15], s63 offen offset:0 nt lds
    v_mfma_f32_16x16x32_bf16 v[176:179], a[196:199], v[88:91], v[176:179]
    ds_read_b64_tr_b16 a[162:163], v20 offset:4352
    v_mfma_f32_16x16x32_bf16 v[208:211], a[196:199], v[92:95], v[208:211]
    ds_read_b64_tr_b16 a[164:165], v20 offset:8
    v_mfma_f32_16x16x32_bf16 v[240:243], a[196:199], v[96:99], v[240:243]
    ds_read_b64_tr_b16 a[166:167], v20 offset:4360
    v_mfma_f32_16x16x32_bf16 v[116:119], a[200:203], v[80:83], v[116:119]
    ds_read_b64_tr_b16 a[168:169], v20 offset:64
    v_mfma_f32_16x16x32_bf16 v[148:151], a[200:203], v[84:87], v[148:151]
    s_add_u32 m0, s67, 32
    ds_read_b64_tr_b16 a[170:171], v20 offset:4416
    v_mfma_f32_16x16x32_bf16 v[180:183], a[200:203], v[88:91], v[180:183]
    buffer_load_dwordx4 v7, s[12:15], s63 offen offset:1024 nt lds
    v_mfma_f32_16x16x32_bf16 v[212:215], a[200:203], v[92:95], v[212:215]
    ds_read_b64_tr_b16 a[172:173], v20 offset:72
    v_mfma_f32_16x16x32_bf16 v[244:247], a[200:203], v[96:99], v[244:247]
    ds_read_b64_tr_b16 a[174:175], v20 offset:4424
    v_mfma_f32_16x16x32_bf16 v[120:123], a[204:207], v[80:83], v[120:123]
    ds_read_b64_tr_b16 a[176:177], v21 offset:0
    v_add_u32 v20, s28, v16
    v_mfma_f32_16x16x32_bf16 v[152:155], a[204:207], v[84:87], v[152:155]
    ds_read_b64_tr_b16 a[178:179], v21 offset:4352
    v_mfma_f32_16x16x32_bf16 v[184:187], a[204:207], v[88:91], v[184:187]
    s_add_u32 m0, s67, 64
    ds_read_b64_tr_b16 a[180:181], v21 offset:8
    v_mfma_f32_16x16x32_bf16 v[216:219], a[204:207], v[92:95], v[216:219]
    buffer_load_dwordx4 v7, s[12:15], s63 offen offset:2048 nt lds
    v_mfma_f32_16x16x32_bf16 v[248:251], a[204:207], v[96:99], v[248:251]
    ds_read_b64_tr_b16 a[182:183], v21 offset:4360
    v_mfma_f32_16x16x32_bf16 v[124:127], a[208:211], v[80:83], v[124:127]
    ds_read_b64_tr_b16 a[184:185], v21 offset:64
    v_mfma_f32_16x16x32_bf16 v[156:159], a[208:211], v[84:87], v[156:159]
    ds_read_b64_tr_b16 a[186:187], v21 offset:4416
    v_mfma_f32_16x16x32_bf16 v[188:191], a[208:211], v[88:91], v[188:191]
    ds_read_b64_tr_b16 a[188:189], v21 offset:72
    v_mfma_f32_16x16x32_bf16 v[220:223], a[208:211], v[92:95], v[220:223]
    s_add_u32 m0, s67, 96
    ds_read_b64_tr_b16 a[190:191], v21 offset:4424
    v_mfma_f32_16x16x32_bf16 v[128:131], a[212:215], v[80:83], v[128:131]
    buffer_load_dwordx4 v7, s[12:15], s63 offen offset:3072 nt lds
    v_mfma_f32_16x16x32_bf16 v[160:163], a[212:215], v[84:87], v[160:163]
    v_add_u32 v21, s28, v17
    v_mfma_f32_16x16x32_bf16 v[192:195], a[212:215], v[88:91], v[192:195]
    v_mfma_f32_16x16x32_bf16 v[224:227], a[212:215], v[92:95], v[224:227]
    v_mfma_f32_16x16x32_bf16 v[132:135], a[216:219], v[80:83], v[132:135]
    v_mfma_f32_16x16x32_bf16 v[164:167], a[216:219], v[84:87], v[164:167]
    v_mfma_f32_16x16x32_bf16 v[196:199], a[216:219], v[88:91], v[196:199]
    v_mfma_f32_16x16x32_bf16 v[228:231], a[216:219], v[92:95], v[228:231]
    v_mfma_f32_16x16x32_bf16 v[136:139], a[220:223], v[80:83], v[136:139]
    v_mfma_f32_16x16x32_bf16 v[168:171], a[220:223], v[84:87], v[168:171]
    v_mfma_f32_16x16x32_bf16 v[200:203], a[220:223], v[88:91], v[200:203]
    s_waitcnt vmcnt(8) lgkmcnt(0)
    v_mfma_f32_16x16x32_bf16 v[232:235], a[220:223], v[92:95], v[232:235]
    s_barrier
    v_mfma_f32_16x16x32_bf16 v[108:111], a[160:163], a[224:227], v[108:111]
    ds_read_b128 v[80:83], v22 offset:0
    v_mfma_f32_16x16x32_bf16 v[140:143], a[160:163], a[228:231], v[140:143]
    ds_read_b128 v[84:87], v22 offset:2048
    v_mfma_f32_16x16x32_bf16 v[172:175], a[160:163], a[232:235], v[172:175]
    ds_read_b128 v[88:91], v22 offset:4096
    v_mfma_f32_16x16x32_bf16 v[204:207], a[160:163], a[236:239], v[204:207]
    ds_read_b128 v[92:95], v22 offset:6144
    v_mfma_f32_16x16x32_bf16 v[236:239], a[160:163], a[240:243], v[236:239]
    s_xor_b32 s63, s48, 0
    ds_read_b128 v[96:99], v23 offset:16384
    v_mfma_f32_16x16x32_bf16 v[112:115], a[164:167], a[224:227], v[112:115]
    s_add_u32 m0, s67, 16896
    ds_read_b64_tr_b16 a[192:193], v20 offset:0
    v_mfma_f32_16x16x32_bf16 v[144:147], a[164:167], a[228:231], v[144:147]
    buffer_load_dwordx4 v7, s[16:19], s63 offen offset:0 nt lds
    v_mfma_f32_16x16x32_bf16 v[176:179], a[164:167], a[232:235], v[176:179]
    ds_read_b64_tr_b16 a[194:195], v20 offset:4352
    v_mfma_f32_16x16x32_bf16 v[208:211], a[164:167], a[236:239], v[208:211]
    ds_read_b64_tr_b16 a[196:197], v20 offset:8
    v_mfma_f32_16x16x32_bf16 v[240:243], a[164:167], a[240:243], v[240:243]
    ds_read_b64_tr_b16 a[198:199], v20 offset:4360
    v_mfma_f32_16x16x32_bf16 v[116:119], a[168:171], a[224:227], v[116:119]
    ds_read_b64_tr_b16 a[200:201], v20 offset:64
    v_mfma_f32_16x16x32_bf16 v[148:151], a[168:171], a[228:231], v[148:151]
    s_add_u32 m0, s67, 16928
    ds_read_b64_tr_b16 a[202:203], v20 offset:4416
    v_mfma_f32_16x16x32_bf16 v[180:183], a[168:171], a[232:235], v[180:183]
    buffer_load_dwordx4 v7, s[16:19], s63 offen offset:1024 nt lds
    v_mfma_f32_16x16x32_bf16 v[212:215], a[168:171], a[236:239], v[212:215]
    ds_read_b64_tr_b16 a[204:205], v20 offset:72
    v_mfma_f32_16x16x32_bf16 v[244:247], a[168:171], a[240:243], v[244:247]
    ds_read_b64_tr_b16 a[206:207], v20 offset:4424
    v_mfma_f32_16x16x32_bf16 v[120:123], a[172:175], a[224:227], v[120:123]
    ds_read_b64_tr_b16 a[208:209], v21 offset:0
    v_mfma_f32_16x16x32_bf16 v[152:155], a[172:175], a[228:231], v[152:155]
    ds_read_b64_tr_b16 a[210:211], v21 offset:4352
    v_mfma_f32_16x16x32_bf16 v[184:187], a[172:175], a[232:235], v[184:187]
    s_add_u32 m0, s67, 16960
    ds_read_b64_tr_b16 a[212:213], v21 offset:8
    v_mfma_f32_16x16x32_bf16 v[216:219], a[172:175], a[236:239], v[216:219]
    buffer_load_dwordx4 v7, s[16:19], s63 offen offset:2048 nt lds
    v_mfma_f32_16x16x32_bf16 v[248:251], a[172:175], a[240:243], v[248:251]
    ds_read_b64_tr_b16 a[214:215], v21 offset:4360
    v_mfma_f32_16x16x32_bf16 v[124:127], a[176:179], a[224:227], v[124:127]
    ds_read_b64_tr_b16 a[216:217], v21 offset:64
    v_mfma_f32_16x16x32_bf16 v[156:159], a[176:179], a[228:231], v[156:159]
    ds_read_b64_tr_b16 a[218:219], v21 offset:4416
    v_mfma_f32_16x16x32_bf16 v[188:191], a[176:179], a[232:235], v[188:191]
    ds_read_b64_tr_b16 a[220:221], v21 offset:72
    v_mfma_f32_16x16x32_bf16 v[220:223], a[176:179], a[236:239], v[220:223]
    s_add_u32 m0, s67, 16992
    ds_read_b64_tr_b16 a[222:223], v21 offset:4424
    v_mfma_f32_16x16x32_bf16 v[128:131], a[180:183], a[224:227], v[128:131]
    buffer_load_dwordx4 v7, s[16:19], s63 offen offset:3072 nt lds
    v_mfma_f32_16x16x32_bf16 v[160:163], a[180:183], a[228:231], v[160:163]
    v_mfma_f32_16x16x32_bf16 v[192:195], a[180:183], a[232:235], v[192:195]
    v_mfma_f32_16x16x32_bf16 v[224:227], a[180:183], a[236:239], v[224:227]
    v_mfma_f32_16x16x32_bf16 v[132:135], a[184:187], a[224:227], v[132:135]
    v_mfma_f32_16x16x32_bf16 v[164:167], a[184:187], a[228:231], v[164:167]
    v_mfma_f32_16x16x32_bf16 v[196:199], a[184:187], a[232:235], v[196:199]
    v_mfma_f32_16x16x32_bf16 v[228:231], a[184:187], a[236:239], v[228:231]
    v_mfma_f32_16x16x32_bf16 v[136:139], a[188:191], a[224:227], v[136:139]
    v_mfma_f32_16x16x32_bf16 v[168:171], a[188:191], a[228:231], v[168:171]
    v_mfma_f32_16x16x32_bf16 v[200:203], a[188:191], a[232:235], v[200:203]
    v_mfma_f32_16x16x32_bf16 v[232:235], a[188:191], a[236:239], v[232:235]
    s_waitcnt lgkmcnt(0)
    v_mfma_f32_16x16x32_bf16 v[236:239], a[192:195], v[96:99], v[236:239]
    v_mfma_f32_16x16x32_bf16 v[240:243], a[196:199], v[96:99], v[240:243]
    v_mfma_f32_16x16x32_bf16 v[244:247], a[200:203], v[96:99], v[244:247]
    v_mfma_f32_16x16x32_bf16 v[248:251], a[204:207], v[96:99], v[248:251]
    s_nop 4
    v_mul_f32 v236, s68, v236
    v_mul_f32 v237, s68, v237
    v_mfma_f32_16x16x32_bf16 v[108:111], a[192:195], v[80:83], v[108:111]
    v_mul_f32 v238, s68, v238
    v_mul_f32 v239, s68, v239
    v_mfma_f32_16x16x32_bf16 v[112:115], a[196:199], v[80:83], v[112:115]
    v_cvt_pk_bf16_f32 v236, v236, v237
    v_cvt_pk_bf16_f32 v237, v238, v239
    v_mfma_f32_16x16x32_bf16 v[116:119], a[200:203], v[80:83], v[116:119]
    v_mul_f32 v240, s68, v240
    v_mul_f32 v241, s68, v241
    v_mfma_f32_16x16x32_bf16 v[120:123], a[204:207], v[80:83], v[120:123]
    v_mul_f32 v242, s68, v242
    v_mul_f32 v243, s68, v243
    v_mfma_f32_16x16x32_bf16 v[124:127], a[208:211], v[80:83], v[124:127]
    v_cvt_pk_bf16_f32 v238, v240, v241
    v_cvt_pk_bf16_f32 v239, v242, v243
    v_mfma_f32_16x16x32_bf16 v[128:131], a[212:215], v[80:83], v[128:131]
    ds_write_b128 v13, v[236:239] offset:20992
    v_mul_f32 v244, s68, v244
    v_mfma_f32_16x16x32_bf16 v[132:135], a[216:219], v[80:83], v[132:135]
    v_mul_f32 v245, s68, v245
    v_mul_f32 v246, s68, v246
    v_mfma_f32_16x16x32_bf16 v[136:139], a[220:223], v[80:83], v[136:139]
    v_mul_f32 v247, s68, v247
    v_cvt_pk_bf16_f32 v240, v244, v245
    v_mfma_f32_16x16x32_bf16 v[140:143], a[192:195], v[84:87], v[140:143]
    v_cvt_pk_bf16_f32 v241, v246, v247
    v_mul_f32 v248, s68, v248
    v_mfma_f32_16x16x32_bf16 v[144:147], a[196:199], v[84:87], v[144:147]
    v_mul_f32 v249, s68, v249
    v_mul_f32 v250, s68, v250
    v_mfma_f32_16x16x32_bf16 v[148:151], a[200:203], v[84:87], v[148:151]
    v_mul_f32 v251, s68, v251
    v_cvt_pk_bf16_f32 v242, v248, v249
    v_mfma_f32_16x16x32_bf16 v[152:155], a[204:207], v[84:87], v[152:155]
    v_cvt_pk_bf16_f32 v243, v250, v251
    ds_write_b128 v13, v[240:243] offset:22016
    v_mfma_f32_16x16x32_bf16 v[156:159], a[208:211], v[84:87], v[156:159]
    v_mul_f32 v108, s68, v108
    v_mul_f32 v109, s68, v109
    v_mfma_f32_16x16x32_bf16 v[160:163], a[212:215], v[84:87], v[160:163]
    v_mul_f32 v110, s68, v110
    v_mul_f32 v111, s68, v111
    v_mfma_f32_16x16x32_bf16 v[164:167], a[216:219], v[84:87], v[164:167]
    v_cvt_pk_bf16_f32 v16, v108, v109
    v_cvt_pk_bf16_f32 v17, v110, v111
    v_mfma_f32_16x16x32_bf16 v[168:171], a[220:223], v[84:87], v[168:171]
    v_mul_f32 v112, s68, v112
    v_mul_f32 v113, s68, v113
    v_mfma_f32_16x16x32_bf16 v[172:175], a[192:195], v[88:91], v[172:175]
    v_mul_f32 v114, s68, v114
    v_mul_f32 v115, s68, v115
    v_mfma_f32_16x16x32_bf16 v[176:179], a[196:199], v[88:91], v[176:179]
    v_cvt_pk_bf16_f32 v18, v112, v113
    v_cvt_pk_bf16_f32 v19, v114, v115
    v_mfma_f32_16x16x32_bf16 v[180:183], a[200:203], v[88:91], v[180:183]
    v_mul_f32 v116, s68, v116
    v_mul_f32 v117, s68, v117
    v_mfma_f32_16x16x32_bf16 v[184:187], a[204:207], v[88:91], v[184:187]
    v_mul_f32 v118, s68, v118
    v_mul_f32 v119, s68, v119
    v_mfma_f32_16x16x32_bf16 v[188:191], a[208:211], v[88:91], v[188:191]
    v_cvt_pk_bf16_f32 v20, v116, v117
    v_cvt_pk_bf16_f32 v21, v118, v119
    v_mfma_f32_16x16x32_bf16 v[192:195], a[212:215], v[88:91], v[192:195]
    v_mul_f32 v120, s68, v120
    v_mul_f32 v121, s68, v121
    v_mfma_f32_16x16x32_bf16 v[196:199], a[216:219], v[88:91], v[196:199]
    v_mul_f32 v122, s68, v122
    v_mul_f32 v123, s68, v123
    v_mfma_f32_16x16x32_bf16 v[200:203], a[220:223], v[88:91], v[200:203]
    v_cvt_pk_bf16_f32 v22, v120, v121
    v_cvt_pk_bf16_f32 v23, v122, v123
    v_mfma_f32_16x16x32_bf16 v[204:207], a[192:195], v[92:95], v[204:207]
    v_mul_f32 v124, s68, v124
    v_mul_f32 v125, s68, v125
    v_mfma_f32_16x16x32_bf16 v[208:211], a[196:199], v[92:95], v[208:211]
    v_mul_f32 v126, s68, v126
    v_mul_f32 v127, s68, v127
    v_mfma_f32_16x16x32_bf16 v[212:215], a[200:203], v[92:95], v[212:215]
    v_cvt_pk_bf16_f32 v24, v124, v125
    v_cvt_pk_bf16_f32 v25, v126, v127
    v_mfma_f32_16x16x32_bf16 v[216:219], a[204:207], v[92:95], v[216:219]
    v_mul_f32 v128, s68, v128
    v_mul_f32 v129, s68, v129
    v_mfma_f32_16x16x32_bf16 v[220:223], a[208:211], v[92:95], v[220:223]
    v_mul_f32 v130, s68, v130
    v_mul_f32 v131, s68, v131
    v_mfma_f32_16x16x32_bf16 v[224:227], a[212:215], v[92:95], v[224:227]
    v_cvt_pk_bf16_f32 v26, v128, v129
    v_cvt_pk_bf16_f32 v27, v130, v131
    v_mfma_f32_16x16x32_bf16 v[228:231], a[216:219], v[92:95], v[228:231]
    v_mul_f32 v132, s68, v132
    v_mul_f32 v133, s68, v133
    v_mfma_f32_16x16x32_bf16 v[232:235], a[220:223], v[92:95], v[232:235]
    v_mul_f32 v134, s68, v134
    v_mul_f32 v135, s68, v135
    v_cvt_pk_bf16_f32 v28, v132, v133
    v_cvt_pk_bf16_f32 v29, v134, v135
    v_mul_f32 v136, s68, v136
    v_mul_f32 v137, s68, v137
    v_mul_f32 v138, s68, v138
    v_mul_f32 v139, s68, v139
    v_cvt_pk_bf16_f32 v30, v136, v137
    v_cvt_pk_bf16_f32 v31, v138, v139
    s_waitcnt vmcnt(8) lgkmcnt(0)
    s_barrier
    ds_read_b128 v[236:239], v9 offset:0
    ds_read_b128 v[240:243], v9 offset:64
    ds_read_b128 v[244:247], v10 offset:0
    ds_read_b128 v[248:251], v10 offset:64
    ds_read_b128 a[192:195], v13 offset:20992
    ds_read_b128 a[196:199], v13 offset:22016
    ds_read_b128 a[200:203], v14 offset:20992
    ds_read_b128 a[204:207], v14 offset:22016
    v_mul_f32 v140, s68, v140
    v_mul_f32 v141, s68, v141
    v_mul_f32 v142, s68, v142
    v_mul_f32 v143, s68, v143
    v_cvt_pk_bf16_f32 v32, v140, v141
    v_cvt_pk_bf16_f32 v33, v142, v143
    s_xor_b32 s63, s48, 16384
    s_add_u32 m0, s67, 50688
    s_nop 0
    buffer_load_dwordx4 v7, s[16:19], s63 offen offset:0 nt lds
    v_mul_f32 v144, s68, v144
    v_mul_f32 v145, s68, v145
    v_mul_f32 v146, s68, v146
    v_mul_f32 v147, s68, v147
    v_cvt_pk_bf16_f32 v34, v144, v145
    v_cvt_pk_bf16_f32 v35, v146, v147
    s_add_u32 m0, s67, 50720
    s_nop 0
    buffer_load_dwordx4 v7, s[16:19], s63 offen offset:1024 nt lds
    v_mul_f32 v148, s68, v148
    v_mul_f32 v149, s68, v149
    v_mul_f32 v150, s68, v150
    v_mul_f32 v151, s68, v151
    v_cvt_pk_bf16_f32 v36, v148, v149
    v_cvt_pk_bf16_f32 v37, v150, v151
    v_mul_f32 v152, s68, v152
    v_mul_f32 v153, s68, v153
    v_mul_f32 v154, s68, v154
    v_mul_f32 v155, s68, v155
    v_cvt_pk_bf16_f32 v38, v152, v153
    v_cvt_pk_bf16_f32 v39, v154, v155
    s_waitcnt lgkmcnt(7)
    v_xor_b32 v236, 0x80008000, v236
    v_xor_b32 v237, 0x80008000, v237
    v_xor_b32 v238, 0x80008000, v238
    v_xor_b32 v239, 0x80008000, v239
    s_waitcnt lgkmcnt(6)
    v_xor_b32 v240, 0x80008000, v240
    v_xor_b32 v241, 0x80008000, v241
    v_mfma_f32_16x16x32_bf16 v[80:83], v[236:239], v[16:19], 0
    v_xor_b32 v242, 0x80008000, v242
    v_xor_b32 v243, 0x80008000, v243
    s_waitcnt lgkmcnt(5)
    v_xor_b32 v244, 0x80008000, v244
    v_xor_b32 v245, 0x80008000, v245
    v_mfma_f32_16x16x32_bf16 v[80:83], v[240:243], v[20:23], v[80:83]
    v_xor_b32 v246, 0x80008000, v246
    v_xor_b32 v247, 0x80008000, v247
    s_waitcnt lgkmcnt(4)
    v_xor_b32 v248, 0x80008000, v248
    v_xor_b32 v249, 0x80008000, v249
    v_mfma_f32_16x16x32_bf16 v[80:83], v[244:247], v[24:27], v[80:83]
    v_xor_b32 v250, 0x80008000, v250
    v_xor_b32 v251, 0x80008000, v251
    v_mul_f32 v156, s68, v156
    v_mul_f32 v157, s68, v157
    v_mfma_f32_16x16x32_bf16 v[80:83], v[248:251], v[28:31], v[80:83]
    v_mul_f32 v158, s68, v158
    v_mul_f32 v159, s68, v159
    v_cvt_pk_bf16_f32 v40, v156, v157
    v_cvt_pk_bf16_f32 v41, v158, v159
    s_waitcnt lgkmcnt(3)
    v_mfma_f32_16x16x32_bf16 v[96:99], v[236:239], a[192:195], 0
    v_mul_f32 v160, s68, v160
    v_mul_f32 v161, s68, v161
    v_mul_f32 v162, s68, v162
    v_mul_f32 v163, s68, v163
    s_waitcnt lgkmcnt(2)
    v_mfma_f32_16x16x32_bf16 v[96:99], v[240:243], a[196:199], v[96:99]
    v_cvt_pk_bf16_f32 v42, v160, v161
    v_cvt_pk_bf16_f32 v43, v162, v163
    v_mul_f32 v164, s68, v164
    v_mul_f32 v165, s68, v165
    s_waitcnt lgkmcnt(1)
    v_mfma_f32_16x16x32_bf16 v[96:99], v[244:247], a[200:203], v[96:99]
    v_mul_f32 v166, s68, v166
    v_mul_f32 v167, s68, v167
    v_cvt_pk_bf16_f32 v44, v164, v165
    v_cvt_pk_bf16_f32 v45, v166, v167
    s_waitcnt lgkmcnt(0)
    v_mfma_f32_16x16x32_bf16 v[96:99], v[248:251], a[204:207], v[96:99]
    v_mul_f32 v168, s68, v168
    v_mul_f32 v169, s68, v169
    v_mul_f32 v170, s68, v170
    v_mul_f32 v171, s68, v171
    v_mfma_f32_16x16x32_bf16 v[84:87], v[236:239], v[32:35], 0
    v_cvt_pk_bf16_f32 v46, v168, v169
    v_cvt_pk_bf16_f32 v47, v170, v171
    v_mul_f32 v172, s68, v172
    v_mul_f32 v173, s68, v173
    v_mfma_f32_16x16x32_bf16 v[84:87], v[240:243], v[36:39], v[84:87]
    v_mul_f32 v174, s68, v174
    v_mul_f32 v175, s68, v175
    v_cvt_pk_bf16_f32 v48, v172, v173
    v_cvt_pk_bf16_f32 v49, v174, v175
    v_mfma_f32_16x16x32_bf16 v[84:87], v[244:247], v[40:43], v[84:87]
    v_mul_f32 v176, s68, v176
    v_mul_f32 v177, s68, v177
    v_mul_f32 v178, s68, v178
    v_mul_f32 v179, s68, v179
    v_mfma_f32_16x16x32_bf16 v[84:87], v[248:251], v[44:47], v[84:87]
    v_cvt_pk_bf16_f32 v50, v176, v177
    v_cvt_pk_bf16_f32 v51, v178, v179
    v_mul_f32 v180, s68, v180
    v_mul_f32 v181, s68, v181
    v_mfma_f32_16x16x32_bf16 v[88:91], v[236:239], v[48:51], 0
    v_mul_f32 v182, s68, v182
    v_mul_f32 v183, s68, v183
    v_cvt_pk_bf16_f32 v52, v180, v181
    v_cvt_pk_bf16_f32 v53, v182, v183
    v_mul_f32 v184, s68, v184
    v_mul_f32 v185, s68, v185
    v_mul_f32 v186, s68, v186
    v_mul_f32 v187, s68, v187
    v_cvt_pk_bf16_f32 v54, v184, v185
    v_cvt_pk_bf16_f32 v55, v186, v187
    v_mul_f32 v188, s68, v188
    v_mul_f32 v189, s68, v189
    v_mfma_f32_16x16x32_bf16 v[88:91], v[240:243], v[52:55], v[88:91]
    v_mul_f32 v190, s68, v190
    v_mul_f32 v191, s68, v191
    v_cvt_pk_bf16_f32 v56, v188, v189
    v_cvt_pk_bf16_f32 v57, v190, v191
    v_mul_f32 v192, s68, v192
    v_mul_f32 v193, s68, v193
    v_mul_f32 v194, s68, v194
    v_mul_f32 v195, s68, v195
    v_cvt_pk_bf16_f32 v58, v192, v193
    v_cvt_pk_bf16_f32 v59, v194, v195
    v_mul_f32 v196, s68, v196
    v_mul_f32 v197, s68, v197
    v_mfma_f32_16x16x32_bf16 v[88:91], v[244:247], v[56:59], v[88:91]
    v_mul_f32 v198, s68, v198
    v_mul_f32 v199, s68, v199
    v_cvt_pk_bf16_f32 v60, v196, v197
    v_cvt_pk_bf16_f32 v61, v198, v199
    v_mul_f32 v200, s68, v200
    v_mul_f32 v201, s68, v201
    v_mul_f32 v202, s68, v202
    v_mul_f32 v203, s68, v203
    v_cvt_pk_bf16_f32 v62, v200, v201
    v_cvt_pk_bf16_f32 v63, v202, v203
    v_mul_f32 v204, s68, v204
    v_mul_f32 v205, s68, v205
    v_mfma_f32_16x16x32_bf16 v[88:91], v[248:251], v[60:63], v[88:91]
    v_mul_f32 v206, s68, v206
    v_mul_f32 v207, s68, v207
    v_cvt_pk_bf16_f32 v64, v204, v205
    v_cvt_pk_bf16_f32 v65, v206, v207
    v_mul_f32 v208, s68, v208
    v_mul_f32 v209, s68, v209
    v_mul_f32 v210, s68, v210
    v_mul_f32 v211, s68, v211
    v_cvt_pk_bf16_f32 v66, v208, v209
    v_cvt_pk_bf16_f32 v67, v210, v211
    v_mul_f32 v212, s68, v212
    v_mul_f32 v213, s68, v213
    v_mfma_f32_16x16x32_bf16 v[92:95], v[236:239], v[64:67], 0
    v_mul_f32 v214, s68, v214
    v_mul_f32 v215, s68, v215
    v_cvt_pk_bf16_f32 v68, v212, v213
    v_cvt_pk_bf16_f32 v69, v214, v215
    v_mul_f32 v216, s68, v216
    ds_read_b128 a[160:163], v1 offset:33792
    ds_read_b128 a[164:167], v1 offset:33856
    ds_read_b128 a[168:171], v2 offset:33792
    ds_read_b128 a[172:175], v2 offset:33856
    v_mul_f32 v217, s68, v217
    v_mul_f32 v218, s68, v218
    v_mul_f32 v219, s68, v219
    v_cvt_pk_bf16_f32 v70, v216, v217
    v_cvt_pk_bf16_f32 v71, v218, v219
    v_mul_f32 v220, s68, v220
    v_mul_f32 v221, s68, v221
    v_mfma_f32_16x16x32_bf16 v[92:95], v[240:243], v[68:71], v[92:95]
    v_mul_f32 v222, s68, v222
    v_mul_f32 v223, s68, v223
    v_cvt_pk_bf16_f32 v72, v220, v221
    v_cvt_pk_bf16_f32 v73, v222, v223
    v_mul_f32 v224, s68, v224
    v_mul_f32 v225, s68, v225
    v_mul_f32 v226, s68, v226
    v_mul_f32 v227, s68, v227
    v_cvt_pk_bf16_f32 v74, v224, v225
    v_cvt_pk_bf16_f32 v75, v226, v227
    v_mul_f32 v228, s68, v228
    v_mul_f32 v229, s68, v229
    v_mfma_f32_16x16x32_bf16 v[92:95], v[244:247], v[72:75], v[92:95]
    v_mul_f32 v230, s68, v230
    v_mul_f32 v231, s68, v231
    v_cvt_pk_bf16_f32 v76, v228, v229
    v_cvt_pk_bf16_f32 v77, v230, v231
    v_mul_f32 v232, s68, v232
    v_mul_f32 v233, s68, v233
    v_mul_f32 v234, s68, v234
    v_mul_f32 v235, s68, v235
    v_cvt_pk_bf16_f32 v78, v232, v233
    v_cvt_pk_bf16_f32 v79, v234, v235
    v_accvgpr_write_b32 a236, 0
    v_accvgpr_write_b32 a237, 0
    v_mfma_f32_16x16x32_bf16 v[92:95], v[248:251], v[76:79], v[92:95]
    v_accvgpr_write_b32 a238, 0
    v_accvgpr_write_b32 a239, 0
    v_accvgpr_write_b32 a240, 0
    v_accvgpr_write_b32 a241, 0
    v_accvgpr_write_b32 a242, 0
    v_accvgpr_write_b32 a243, 0
K1_ATT:
    s_mov_b32 s33, 8
    s_waitcnt lgkmcnt(3)
    v_mfma_f32_16x16x32_bf16 v[108:111], a[160:163], v[16:19], v[80:83]
    s_waitcnt lgkmcnt(2)
    v_mfma_f32_16x16x32_bf16 v[108:111], a[164:167], v[20:23], v[108:111]
    s_waitcnt lgkmcnt(1)
    v_mfma_f32_16x16x32_bf16 v[108:111], a[168:171], v[24:27], v[108:111]
    s_waitcnt lgkmcnt(0)
    v_mfma_f32_16x16x32_bf16 v[108:111], a[172:175], v[28:31], v[108:111]
    v_mfma_f32_16x16x32_bf16 v[112:115], a[160:163], v[32:35], v[84:87]
    v_mfma_f32_16x16x32_bf16 v[112:115], a[164:167], v[36:39], v[112:115]
    v_mfma_f32_16x16x32_bf16 v[112:115], a[168:171], v[40:43], v[112:115]
    v_mfma_f32_16x16x32_bf16 v[112:115], a[172:175], v[44:47], v[112:115]
    v_mfma_f32_16x16x32_bf16 v[116:119], a[160:163], v[48:51], v[88:91]
    v_mfma_f32_16x16x32_bf16 v[116:119], a[164:167], v[52:55], v[116:119]
    v_mfma_f32_16x16x32_bf16 v[116:119], a[168:171], v[56:59], v[116:119]
    v_mfma_f32_16x16x32_bf16 v[116:119], a[172:175], v[60:63], v[116:119]
    v_mfma_f32_16x16x32_bf16 v[120:123], a[160:163], v[64:67], v[92:95]
    v_mfma_f32_16x16x32_bf16 v[120:123], a[164:167], v[68:71], v[120:123]
    v_exp_f32 v108, v108
    v_mfma_f32_16x16x32_bf16 v[120:123], a[168:171], v[72:75], v[120:123]
    v_mfma_f32_16x16x32_bf16 v[120:123], a[172:175], v[76:79], v[120:123]
    v_exp_f32 v109, v109
    v_mfma_f32_16x16x32_bf16 v[124:127], a[160:163], a[192:195], v[96:99]
    v_mfma_f32_16x16x32_bf16 v[124:127], a[164:167], a[196:199], v[124:127]
    v_exp_f32 v110, v110
    v_mfma_f32_16x16x32_bf16 v[124:127], a[168:171], a[200:203], v[124:127]
    v_mfma_f32_16x16x32_bf16 v[124:127], a[172:175], a[204:207], v[124:127]
    v_exp_f32 v111, v111
    ds_read_b128 a[160:163], v1 offset:34048
    v_exp_f32 v112, v112
    ds_read_b128 a[164:167], v1 offset:34112
    v_exp_f32 v113, v113
    ds_read_b128 a[168:171], v2 offset:34048
    v_cvt_pk_bf16_f32 v148, v108, v109
    v_exp_f32 v114, v114
    ds_read_b128 a[172:175], v2 offset:34112
    v_cvt_pk_bf16_f32 v149, v110, v111
    v_exp_f32 v115, v115
    v_add_f32 v101, v101, v112
    v_cvt_pk_bf16_f32 v156, v112, v113
    s_add_u32 m0, s35, 50752
    v_exp_f32 v116, v116
    buffer_load_dwordx4 v7, s[16:19], s49 offen offset:2048 nt lds
    s_add_u32 m0, s35, 50784
    v_exp_f32 v117, v117
    buffer_load_dwordx4 v7, s[16:19], s49 offen offset:3072 nt lds
    v_exp_f32 v118, v118
    v_add_f32 v101, v101, v113
    v_add_f32 v101, v101, v114
    v_exp_f32 v119, v119
    v_cvt_pk_bf16_f32 v157, v114, v115
    v_add_f32 v101, v101, v115
    s_waitcnt lgkmcnt(0)
    v_exp_f32 v120, v120
    v_mfma_f32_16x16x32_bf16 v[128:131], a[160:163], v[16:19], v[80:83]
    v_add_f32 v102, v102, v116
    v_mfma_f32_16x16x32_bf16 v[128:131], a[164:167], v[20:23], v[128:131]
    v_exp_f32 v121, v121
    v_mfma_f32_16x16x32_bf16 v[128:131], a[168:171], v[24:27], v[128:131]
    v_cvt_pk_bf16_f32 v164, v116, v117
    v_mfma_f32_16x16x32_bf16 v[128:131], a[172:175], v[28:31], v[128:131]
    s_add_u32 s38, s38, 16384
    v_exp_f32 v122, v122
    v_mfma_f32_16x16x32_bf16 v[132:135], a[160:163], v[32:35], v[84:87]
    v_add_f32 v102, v102, v117
    v_mfma_f32_16x16x32_bf16 v[132:135], a[164:167], v[36:39], v[132:135]
    s_xor_b32 s49, s38, s48
    v_exp_f32 v123, v123
    v_mfma_f32_16x16x32_bf16 v[132:135], a[168:171], v[40:43], v[132:135]
    v_add_f32 v102, v102, v118
    v_mfma_f32_16x16x32_bf16 v[132:135], a[172:175], v[44:47], v[132:135]
    v_exp_f32 v124, v124
    v_mfma_f32_16x16x32_bf16 v[136:139], a[160:163], v[48:51], v[88:91]
    v_cvt_pk_bf16_f32 v165, v118, v119
    v_mfma_f32_16x16x32_bf16 v[136:139], a[164:167], v[52:55], v[136:139]
    v_exp_f32 v125, v125
    v_mfma_f32_16x16x32_bf16 v[136:139], a[168:171], v[56:59], v[136:139]
    v_add_f32 v102, v102, v119
    v_mfma_f32_16x16x32_bf16 v[136:139], a[172:175], v[60:63], v[136:139]
    v_exp_f32 v126, v126
    v_mfma_f32_16x16x32_bf16 v[140:143], a[160:163], v[64:67], v[92:95]
    v_add_f32 v103, v103, v120
    v_mfma_f32_16x16x32_bf16 v[140:143], a[164:167], v[68:71], v[140:143]
    v_exp_f32 v127, v127
    v_mfma_f32_16x16x32_bf16 v[140:143], a[168:171], v[72:75], v[140:143]
    v_cvt_pk_bf16_f32 v172, v120, v121
    v_mfma_f32_16x16x32_bf16 v[140:143], a[172:175], v[76:79], v[140:143]
    v_exp_f32 v128, v128
    v_mfma_f32_16x16x32_bf16 v[144:147], a[160:163], a[192:195], v[96:99]
    v_add_f32 v103, v103, v121
    v_add_f32 v103, v103, v122
    v_mfma_f32_16x16x32_bf16 v[144:147], a[164:167], a[196:199], v[144:147]
    v_exp_f32 v129, v129
    v_mfma_f32_16x16x32_bf16 v[144:147], a[168:171], a[200:203], v[144:147]
    v_cvt_pk_bf16_f32 v173, v122, v123
    v_add_f32 v103, v103, v123
    v_mfma_f32_16x16x32_bf16 v[144:147], a[172:175], a[204:207], v[144:147]
    v_exp_f32 v130, v130
    ds_read_b128 a[160:163], v3 offset:33792
    v_cvt_pk_bf16_f32 v180, v124, v125
    v_exp_f32 v131, v131
    ds_read_b128 a[164:167], v3 offset:33856
    v_cvt_pk_bf16_f32 v181, v126, v127
    v_exp_f32 v132, v132
    ds_read_b128 a[168:171], v4 offset:33792
    v_cvt_pk_bf16_f32 v150, v128, v129
    v_exp_f32 v133, v133
    ds_read_b128 a[172:175], v4 offset:33856
    v_cvt_pk_bf16_f32 v151, v130, v131
    v_exp_f32 v134, v134
    v_add_f32 v101, v101, v132
    v_cvt_pk_bf16_f32 v158, v132, v133
    s_add_u32 m0, s35, 33792
    v_exp_f32 v135, v135
    buffer_load_dwordx4 v7, s[12:15], s69 offen offset:0 nt lds
    s_add_u32 m0, s35, 33824
    v_exp_f32 v136, v136
    buffer_load_dwordx4 v7, s[12:15], s69 offen offset:1024 nt lds
    v_exp_f32 v137, v137
    v_add_f32 v101, v101, v133
    v_add_f32 v101, v101, v134
    v_cvt_pk_bf16_f32 v159, v134, v135
    v_add_f32 v101, v101, v135
    v_add_f32 v102, v102, v136
    v_cvt_pk_bf16_f32 v166, v136, v137
    s_waitcnt lgkmcnt(0)
    v_exp_f32 v138, v138
    v_mfma_f32_16x16x32_bf16 v[108:111], a[160:163], v[16:19], v[80:83]
    v_add_f32 v102, v102, v137
    v_mfma_f32_16x16x32_bf16 v[108:111], a[164:167], v[20:23], v[108:111]
    v_exp_f32 v139, v139
    v_mfma_f32_16x16x32_bf16 v[108:111], a[168:171], v[24:27], v[108:111]
    v_add_f32 v102, v102, v138
    v_mfma_f32_16x16x32_bf16 v[108:111], a[172:175], v[28:31], v[108:111]
    v_exp_f32 v140, v140
    v_mfma_f32_16x16x32_bf16 v[112:115], a[160:163], v[32:35], v[84:87]
    v_cvt_pk_bf16_f32 v167, v138, v139
    v_mfma_f32_16x16x32_bf16 v[112:115], a[164:167], v[36:39], v[112:115]
    v_exp_f32 v141, v141
    v_mfma_f32_16x16x32_bf16 v[112:115], a[168:171], v[40:43], v[112:115]
    v_add_f32 v102, v102, v139
    v_mfma_f32_16x16x32_bf16 v[112:115], a[172:175], v[44:47], v[112:115]
    v_exp_f32 v142, v142
    v_mfma_f32_16x16x32_bf16 v[116:119], a[160:163], v[48:51], v[88:91]
    v_add_f32 v103, v103, v140
    v_mfma_f32_16x16x32_bf16 v[116:119], a[164:167], v[52:55], v[116:119]
    v_exp_f32 v143, v143
    v_mfma_f32_16x16x32_bf16 v[116:119], a[168:171], v[56:59], v[116:119]
    v_cvt_pk_bf16_f32 v174, v140, v141
    v_mfma_f32_16x16x32_bf16 v[116:119], a[172:175], v[60:63], v[116:119]
    v_exp_f32 v144, v144
    v_mfma_f32_16x16x32_bf16 v[120:123], a[160:163], v[64:67], v[92:95]
    v_add_f32 v103, v103, v141
    v_mfma_f32_16x16x32_bf16 v[120:123], a[164:167], v[68:71], v[120:123]
    v_exp_f32 v145, v145
    v_mfma_f32_16x16x32_bf16 v[120:123], a[168:171], v[72:75], v[120:123]
    v_add_f32 v103, v103, v142
    v_mfma_f32_16x16x32_bf16 v[120:123], a[172:175], v[76:79], v[120:123]
    v_exp_f32 v146, v146
    v_cvt_pk_bf16_f32 v175, v142, v143
    v_add_f32 v103, v103, v143
    v_exp_f32 v147, v147
    ds_read_b128 a[160:163], v3 offset:34048
    v_cvt_pk_bf16_f32 v182, v144, v145
    v_exp_f32 v108, v108
    ds_read_b128 a[164:167], v3 offset:34112
    v_cvt_pk_bf16_f32 v183, v146, v147
    v_exp_f32 v109, v109
    ds_read_b128 a[168:171], v4 offset:34048
    v_cvt_pk_bf16_f32 v152, v108, v109
    v_exp_f32 v110, v110
    ds_read_b128 a[172:175], v4 offset:34112
    v_exp_f32 v111, v111
    s_nop 0
    v_cvt_pk_bf16_f32 v153, v110, v111
    v_subrev_u32 v1, 101376, v1
    s_add_u32 m0, s35, 33856
    v_exp_f32 v112, v112
    buffer_load_dwordx4 v7, s[12:15], s69 offen offset:2048 nt lds
    s_add_u32 m0, s35, 33888
    v_exp_f32 v113, v113
    buffer_load_dwordx4 v7, s[12:15], s69 offen offset:3072 nt lds
    v_exp_f32 v114, v114
    v_add_f32 v101, v101, v112
    v_cvt_pk_bf16_f32 v160, v112, v113
    v_exp_f32 v115, v115
    v_add_f32 v101, v101, v113
    v_add_f32 v101, v101, v114
    s_waitcnt lgkmcnt(0)
    v_exp_f32 v116, v116
    v_mfma_f32_16x16x32_bf16 v[128:131], a[160:163], v[16:19], v[80:83]
    v_cvt_pk_bf16_f32 v161, v114, v115
    v_subrev_u32 v2, 101376, v2
    v_mfma_f32_16x16x32_bf16 v[128:131], a[164:167], v[20:23], v[128:131]
    v_exp_f32 v117, v117
    v_mfma_f32_16x16x32_bf16 v[128:131], a[168:171], v[24:27], v[128:131]
    v_add_f32 v101, v101, v115
    v_subrev_u32 v3, 101376, v3
    v_mfma_f32_16x16x32_bf16 v[128:131], a[172:175], v[28:31], v[128:131]
    s_add_u32 s39, s39, 16384
    v_exp_f32 v118, v118
    v_mfma_f32_16x16x32_bf16 v[132:135], a[160:163], v[32:35], v[84:87]
    v_add_f32 v102, v102, v116
    v_subrev_u32 v4, 101376, v4
    v_mfma_f32_16x16x32_bf16 v[132:135], a[164:167], v[36:39], v[132:135]
    s_xor_b32 s69, s39, s48
    v_exp_f32 v119, v119
    v_mfma_f32_16x16x32_bf16 v[132:135], a[168:171], v[40:43], v[132:135]
    v_cvt_pk_bf16_f32 v168, v116, v117
    v_mfma_f32_16x16x32_bf16 v[132:135], a[172:175], v[44:47], v[132:135]
    v_exp_f32 v120, v120
    v_mfma_f32_16x16x32_bf16 v[136:139], a[160:163], v[48:51], v[88:91]
    v_add_f32 v102, v102, v117
    v_mfma_f32_16x16x32_bf16 v[136:139], a[164:167], v[52:55], v[136:139]
    v_exp_f32 v121, v121
    v_mfma_f32_16x16x32_bf16 v[136:139], a[168:171], v[56:59], v[136:139]
    v_add_f32 v102, v102, v118
    v_mfma_f32_16x16x32_bf16 v[136:139], a[172:175], v[60:63], v[136:139]
    v_exp_f32 v122, v122
    v_mfma_f32_16x16x32_bf16 v[140:143], a[160:163], v[64:67], v[92:95]
    v_cvt_pk_bf16_f32 v169, v118, v119
    v_mfma_f32_16x16x32_bf16 v[140:143], a[164:167], v[68:71], v[140:143]
    v_exp_f32 v123, v123
    v_mfma_f32_16x16x32_bf16 v[140:143], a[168:171], v[72:75], v[140:143]
    v_add_f32 v102, v102, v119
    v_mfma_f32_16x16x32_bf16 v[140:143], a[172:175], v[76:79], v[140:143]
    v_exp_f32 v128, v128
    v_add_f32 v103, v103, v120
    v_cvt_pk_bf16_f32 v176, v120, v121
    s_waitcnt vmcnt(8)
    v_exp_f32 v129, v129
    s_barrier
    v_add_f32 v103, v103, v121
    v_add_f32 v103, v103, v122
    ds_read_b128 a[160:163], v1 offset:0
    v_cvt_pk_bf16_f32 v177, v122, v123
    v_exp_f32 v130, v130
    ds_read_b128 a[164:167], v1 offset:64
    v_add_f32 v103, v103, v123
    v_exp_f32 v131, v131
    ds_read_b128 a[168:171], v2 offset:0
    v_cvt_pk_bf16_f32 v154, v128, v129
    v_exp_f32 v132, v132
    ds_read_b128 a[172:175], v2 offset:64
    v_cvt_pk_bf16_f32 v155, v130, v131
    s_add_u32 m0, s34, 16896
    v_exp_f32 v133, v133
    buffer_load_dwordx4 v7, s[16:19], s49 offen offset:0 nt lds
    s_add_u32 m0, s34, 16928
    v_exp_f32 v134, v134
    buffer_load_dwordx4 v7, s[16:19], s49 offen offset:1024 nt lds
    v_exp_f32 v135, v135
    s_xor_b32 s34, s34, s36
    v_add_f32 v101, v101, v132
    v_cvt_pk_bf16_f32 v162, v132, v133
    s_xor_b32 s35, s35, s36
    v_exp_f32 v136, v136
    v_add_f32 v101, v101, v133
    v_add_f32 v101, v101, v134
    s_waitcnt lgkmcnt(0)
    v_exp_f32 v137, v137
K1_ALOOP:
    v_mfma_f32_16x16x32_bf16 v[108:111], a[160:163], v[16:19], v[80:83]
    ds_read_b64_tr_b16 a[176:177], v5 offset:16896
    v_cvt_pk_bf16_f32 v163, v134, v135
    v_mfma_f32_16x16x32_bf16 v[108:111], a[164:167], v[20:23], v[108:111]
    v_exp_f32 v138, v138
    v_mfma_f32_16x16x32_bf16 v[108:111], a[168:171], v[24:27], v[108:111]
    ds_read_b64_tr_b16 a[178:179], v5 offset:17152
    v_add_f32 v101, v101, v135
    v_mfma_f32_16x16x32_bf16 v[108:111], a[172:175], v[28:31], v[108:111]
    v_exp_f32 v139, v139
    v_mfma_f32_16x16x32_bf16 v[112:115], a[160:163], v[32:35], v[84:87]
    ds_read_b64_tr_b16 a[180:181], v6 offset:16896
    v_add_f32 v102, v102, v136
    v_mfma_f32_16x16x32_bf16 v[112:115], a[164:167], v[36:39], v[112:115]
    v_exp_f32 v140, v140
    v_mfma_f32_16x16x32_bf16 v[112:115], a[168:171], v[40:43], v[112:115]
    ds_read_b64_tr_b16 a[182:183], v6 offset:17152
    v_cvt_pk_bf16_f32 v170, v136, v137
    v_mfma_f32_16x16x32_bf16 v[112:115], a[172:175], v[44:47], v[112:115]
    v_exp_f32 v141, v141
    v_mfma_f32_16x16x32_bf16 v[116:119], a[160:163], v[48:51], v[88:91]
    ds_read_b64_tr_b16 a[184:185], v5 offset:16928
    v_add_f32 v102, v102, v137
    v_mfma_f32_16x16x32_bf16 v[116:119], a[164:167], v[52:55], v[116:119]
    v_exp_f32 v142, v142
    v_mfma_f32_16x16x32_bf16 v[116:119], a[168:171], v[56:59], v[116:119]
    ds_read_b64_tr_b16 a[186:187], v5 offset:17184
    v_add_f32 v102, v102, v138
    v_mfma_f32_16x16x32_bf16 v[116:119], a[172:175], v[60:63], v[116:119]
    v_exp_f32 v143, v143
    v_mfma_f32_16x16x32_bf16 v[120:123], a[160:163], v[64:67], v[92:95]
    ds_read_b64_tr_b16 a[188:189], v6 offset:16928
    v_cvt_pk_bf16_f32 v171, v138, v139
    v_mfma_f32_16x16x32_bf16 v[120:123], a[164:167], v[68:71], v[120:123]
    v_exp_f32 v108, v108
    v_mfma_f32_16x16x32_bf16 v[120:123], a[168:171], v[72:75], v[120:123]
    ds_read_b64_tr_b16 a[190:191], v6 offset:17184
    v_add_f32 v102, v102, v139
    v_mfma_f32_16x16x32_bf16 v[120:123], a[172:175], v[76:79], v[120:123]
    v_exp_f32 v109, v109
    v_mfma_f32_16x16x32_bf16 v[124:127], a[160:163], a[192:195], v[96:99]
    v_add_f32 v103, v103, v140
    v_cvt_pk_bf16_f32 v178, v140, v141
    v_mfma_f32_16x16x32_bf16 v[124:127], a[164:167], a[196:199], v[124:127]
    v_exp_f32 v110, v110
    v_mfma_f32_16x16x32_bf16 v[124:127], a[168:171], a[200:203], v[124:127]
    v_add_f32 v103, v103, v141
    v_add_f32 v103, v103, v142
    v_mfma_f32_16x16x32_bf16 v[124:127], a[172:175], a[204:207], v[124:127]
    s_waitcnt lgkmcnt(4)
    v_exp_f32 v111, v111
    v_mfma_f32_16x16x32_bf16 a[0:3], a[176:179], v[148:151], a[0:3]
    ds_read_b128 a[160:163], v1 offset:256
    v_cvt_pk_bf16_f32 v179, v142, v143
    v_mfma_f32_16x16x32_bf16 a[0:3], a[180:183], v[152:155], a[0:3]
    v_exp_f32 v112, v112
    v_mfma_f32_16x16x32_bf16 a[32:35], a[176:179], v[156:159], a[32:35]
    ds_read_b128 a[164:167], v1 offset:320
    v_add_f32 v103, v103, v143
    v_mfma_f32_16x16x32_bf16 a[32:35], a[180:183], v[160:163], a[32:35]
    v_exp_f32 v113, v113
    v_mfma_f32_16x16x32_bf16 a[64:67], a[176:179], v[164:167], a[64:67]
    ds_read_b128 a[168:171], v2 offset:256
    v_cvt_pk_bf16_f32 v184, v108, v109
    v_mfma_f32_16x16x32_bf16 a[64:67], a[180:183], v[168:171], a[64:67]
    v_exp_f32 v114, v114
    v_mfma_f32_16x16x32_bf16 a[96:99], a[176:179], v[172:175], a[96:99]
    ds_read_b128 a[172:175], v2 offset:320
    v_cvt_pk_bf16_f32 v185, v110, v111
    v_mfma_f32_16x16x32_bf16 a[96:99], a[180:183], v[176:179], a[96:99]
    v_exp_f32 v115, v115
    v_mfma_f32_16x16x32_bf16 a[128:131], a[176:179], v[180:183], a[128:131]
    s_waitcnt lgkmcnt(4)
    v_add_f32 v101, v101, v112
    v_cvt_pk_bf16_f32 v192, v112, v113
    v_mfma_f32_16x16x32_bf16 a[4:7], a[184:187], v[148:151], a[4:7]
    s_add_u32 m0, s35, 16960
    v_exp_f32 v116, v116
    v_mfma_f32_16x16x32_bf16 a[4:7], a[188:191], v[152:155], a[4:7]
    buffer_load_dwordx4 v7, s[16:19], s49 offen offset:2048 nt lds
    v_mfma_f32_16x16x32_bf16 a[36:39], a[184:187], v[156:159], a[36:39]
    s_add_u32 m0, s35, 16992
    v_exp_f32 v117, v117
    v_mfma_f32_16x16x32_bf16 a[36:39], a[188:191], v[160:163], a[36:39]
    buffer_load_dwordx4 v7, s[16:19], s49 offen offset:3072 nt lds
    v_mfma_f32_16x16x32_bf16 a[68:71], a[184:187], v[164:167], a[68:71]
    v_exp_f32 v118, v118
    v_mfma_f32_16x16x32_bf16 a[68:71], a[188:191], v[168:171], a[68:71]
    v_add_f32 v101, v101, v113
    v_add_f32 v101, v101, v114
    v_mfma_f32_16x16x32_bf16 a[100:103], a[184:187], v[172:175], a[100:103]
    v_exp_f32 v119, v119
    v_mfma_f32_16x16x32_bf16 a[100:103], a[188:191], v[176:179], a[100:103]
    v_cvt_pk_bf16_f32 v193, v114, v115
    v_add_f32 v101, v101, v115
    v_mfma_f32_16x16x32_bf16 a[132:135], a[184:187], v[180:183], a[132:135]
    s_waitcnt lgkmcnt(0)
    v_exp_f32 v120, v120
    v_mfma_f32_16x16x32_bf16 v[128:131], a[160:163], v[16:19], v[80:83]
    ds_read_b64_tr_b16 a[176:177], v5 offset:16960
    v_add_f32 v102, v102, v116
    v_mfma_f32_16x16x32_bf16 v[128:131], a[164:167], v[20:23], v[128:131]
    v_exp_f32 v121, v121
    v_mfma_f32_16x16x32_bf16 v[128:131], a[168:171], v[24:27], v[128:131]
    ds_read_b64_tr_b16 a[178:179], v5 offset:17216
    v_cvt_pk_bf16_f32 v200, v116, v117
    v_mfma_f32_16x16x32_bf16 v[128:131], a[172:175], v[28:31], v[128:131]
    s_add_u32 s38, s38, 16384
    v_exp_f32 v122, v122
    v_mfma_f32_16x16x32_bf16 v[132:135], a[160:163], v[32:35], v[84:87]
    ds_read_b64_tr_b16 a[180:181], v6 offset:16960
    v_add_f32 v102, v102, v117
    v_mfma_f32_16x16x32_bf16 v[132:135], a[164:167], v[36:39], v[132:135]
    s_xor_b32 s49, s38, s48
    v_exp_f32 v123, v123
    v_mfma_f32_16x16x32_bf16 v[132:135], a[168:171], v[40:43], v[132:135]
    ds_read_b64_tr_b16 a[182:183], v6 offset:17216
    v_add_f32 v102, v102, v118
    v_mfma_f32_16x16x32_bf16 v[132:135], a[172:175], v[44:47], v[132:135]
    v_exp_f32 v124, v124
    v_mfma_f32_16x16x32_bf16 v[136:139], a[160:163], v[48:51], v[88:91]
    ds_read_b64_tr_b16 a[184:185], v5 offset:16992
    v_cvt_pk_bf16_f32 v201, v118, v119
    v_mfma_f32_16x16x32_bf16 v[136:139], a[164:167], v[52:55], v[136:139]
    v_exp_f32 v125, v125
    v_mfma_f32_16x16x32_bf16 v[136:139], a[168:171], v[56:59], v[136:139]
    ds_read_b64_tr_b16 a[186:187], v5 offset:17248
    v_add_f32 v102, v102, v119
    v_mfma_f32_16x16x32_bf16 v[136:139], a[172:175], v[60:63], v[136:139]
    v_exp_f32 v126, v126
    v_mfma_f32_16x16x32_bf16 v[140:143], a[160:163], v[64:67], v[92:95]
    ds_read_b64_tr_b16 a[188:189], v6 offset:16992
    v_add_f32 v103, v103, v120
    v_mfma_f32_16x16x32_bf16 v[140:143], a[164:167], v[68:71], v[140:143]
    v_exp_f32 v127, v127
    v_mfma_f32_16x16x32_bf16 v[140:143], a[168:171], v[72:75], v[140:143]
    ds_read_b64_tr_b16 a[190:191], v6 offset:17248
    v_cvt_pk_bf16_f32 v208, v120, v121
    v_mfma_f32_16x16x32_bf16 v[140:143], a[172:175], v[76:79], v[140:143]
    v_exp_f32 v128, v128
    v_mfma_f32_16x16x32_bf16 v[144:147], a[160:163], a[192:195], v[96:99]
    v_add_f32 v103, v103, v121
    v_add_f32 v103, v103, v122
    v_mfma_f32_16x16x32_bf16 v[144:147], a[164:167], a[196:199], v[144:147]
    v_exp_f32 v129, v129
    v_mfma_f32_16x16x32_bf16 v[144:147], a[168:171], a[200:203], v[144:147]
    v_cvt_pk_bf16_f32 v209, v122, v123
    v_add_f32 v103, v103, v123
    v_mfma_f32_16x16x32_bf16 v[144:147], a[172:175], a[204:207], v[144:147]
    s_waitcnt lgkmcnt(4)
    v_exp_f32 v130, v130
    v_mfma_f32_16x16x32_bf16 a[8:11], a[176:179], v[148:151], a[8:11]
    ds_read_b128 a[160:163], v3 offset:0
    v_cvt_pk_bf16_f32 v216, v124, v125
    v_mfma_f32_16x16x32_bf16 a[8:11], a[180:183], v[152:155], a[8:11]
    v_exp_f32 v131, v131
    v_mfma_f32_16x16x32_bf16 a[40:43], a[176:179], v[156:159], a[40:43]
    ds_read_b128 a[164:167], v3 offset:64
    v_cvt_pk_bf16_f32 v217, v126, v127
    v_mfma_f32_16x16x32_bf16 a[40:43], a[180:183], v[160:163], a[40:43]
    v_exp_f32 v132, v132
    v_mfma_f32_16x16x32_bf16 a[72:75], a[176:179], v[164:167], a[72:75]
    ds_read_b128 a[168:171], v4 offset:0
    v_cvt_pk_bf16_f32 v186, v128, v129
    v_mfma_f32_16x16x32_bf16 a[72:75], a[180:183], v[168:171], a[72:75]
    v_exp_f32 v133, v133
    v_mfma_f32_16x16x32_bf16 a[104:107], a[176:179], v[172:175], a[104:107]
    ds_read_b128 a[172:175], v4 offset:64
    v_cvt_pk_bf16_f32 v187, v130, v131
    v_mfma_f32_16x16x32_bf16 a[104:107], a[180:183], v[176:179], a[104:107]
    v_exp_f32 v134, v134
    v_mfma_f32_16x16x32_bf16 a[136:139], a[176:179], v[180:183], a[136:139]
    s_waitcnt lgkmcnt(4)
    v_add_f32 v101, v101, v132
    v_cvt_pk_bf16_f32 v194, v132, v133
    v_mfma_f32_16x16x32_bf16 a[12:15], a[184:187], v[148:151], a[12:15]
    s_add_u32 m0, s35, 0
    v_exp_f32 v135, v135
    v_mfma_f32_16x16x32_bf16 a[12:15], a[188:191], v[152:155], a[12:15]
    buffer_load_dwordx4 v7, s[12:15], s69 offen offset:0 nt lds
    v_mfma_f32_16x16x32_bf16 a[44:47], a[184:187], v[156:159], a[44:47]
    s_add_u32 m0, s35, 32
    v_exp_f32 v136, v136
    v_mfma_f32_16x16x32_bf16 a[44:47], a[188:191], v[160:163], a[44:47]
    buffer_load_dwordx4 v7, s[12:15], s69 offen offset:1024 nt lds
    v_mfma_f32_16x16x32_bf16 a[76:79], a[184:187], v[164:167], a[76:79]
    v_exp_f32 v137, v137
    v_mfma_f32_16x16x32_bf16 a[76:79], a[188:191], v[168:171], a[76:79]
    v_add_f32 v101, v101, v133
    v_add_f32 v101, v101, v134
    v_mfma_f32_16x16x32_bf16 a[108:111], a[184:187], v[172:175], a[108:111]
    v_cvt_pk_bf16_f32 v195, v134, v135
    v_add_f32 v101, v101, v135
    v_mfma_f32_16x16x32_bf16 a[108:111], a[188:191], v[176:179], a[108:111]
    v_add_f32 v102, v102, v136
    v_cvt_pk_bf16_f32 v202, v136, v137
    v_mfma_f32_16x16x32_bf16 a[140:143], a[184:187], v[180:183], a[140:143]
    s_waitcnt lgkmcnt(0)
    v_exp_f32 v138, v138
    v_mfma_f32_16x16x32_bf16 v[108:111], a[160:163], v[16:19], v[80:83]
    ds_read_b64_tr_b16 a[176:177], v5 offset:17024
    v_add_f32 v102, v102, v137
    v_mfma_f32_16x16x32_bf16 v[108:111], a[164:167], v[20:23], v[108:111]
    v_exp_f32 v139, v139
    v_mfma_f32_16x16x32_bf16 v[108:111], a[168:171], v[24:27], v[108:111]
    ds_read_b64_tr_b16 a[178:179], v5 offset:17280
    v_add_f32 v102, v102, v138
    v_mfma_f32_16x16x32_bf16 v[108:111], a[172:175], v[28:31], v[108:111]
    v_exp_f32 v140, v140
    v_mfma_f32_16x16x32_bf16 v[112:115], a[160:163], v[32:35], v[84:87]
    ds_read_b64_tr_b16 a[180:181], v6 offset:17024
    v_cvt_pk_bf16_f32 v203, v138, v139
    v_mfma_f32_16x16x32_bf16 v[112:115], a[164:167], v[36:39], v[112:115]
    v_exp_f32 v141, v141
    v_mfma_f32_16x16x32_bf16 v[112:115], a[168:171], v[40:43], v[112:115]
    ds_read_b64_tr_b16 a[182:183], v6 offset:17280
    v_add_f32 v102, v102, v139
    v_mfma_f32_16x16x32_bf16 v[112:115], a[172:175], v[44:47], v[112:115]
    v_exp_f32 v142, v142
    v_mfma_f32_16x16x32_bf16 v[116:119], a[160:163], v[48:51], v[88:91]
    ds_read_b64_tr_b16 a[184:185], v5 offset:17056
    v_add_f32 v103, v103, v140
    v_mfma_f32_16x16x32_bf16 v[116:119], a[164:167], v[52:55], v[116:119]
    v_exp_f32 v143, v143
    v_mfma_f32_16x16x32_bf16 v[116:119], a[168:171], v[56:59], v[116:119]
    ds_read_b64_tr_b16 a[186:187], v5 offset:17312
    v_cvt_pk_bf16_f32 v210, v140, v141
    v_mfma_f32_16x16x32_bf16 v[116:119], a[172:175], v[60:63], v[116:119]
    v_exp_f32 v144, v144
    v_mfma_f32_16x16x32_bf16 v[120:123], a[160:163], v[64:67], v[92:95]
    ds_read_b64_tr_b16 a[188:189], v6 offset:17056
    v_add_f32 v103, v103, v141
    v_mfma_f32_16x16x32_bf16 v[120:123], a[164:167], v[68:71], v[120:123]
    v_exp_f32 v145, v145
    v_mfma_f32_16x16x32_bf16 v[120:123], a[168:171], v[72:75], v[120:123]
    ds_read_b64_tr_b16 a[190:191], v6 offset:17312
    v_add_f32 v103, v103, v142
    v_mfma_f32_16x16x32_bf16 v[120:123], a[172:175], v[76:79], v[120:123]
    v_exp_f32 v146, v146
    v_mfma_f32_16x16x32_bf16 a[236:239], v[252:255], v[148:151], a[236:239]
    v_cvt_pk_bf16_f32 v211, v142, v143
    v_add_f32 v103, v103, v143
    v_mfma_f32_16x16x32_bf16 a[236:239], v[252:255], v[152:155], a[236:239]
    s_waitcnt lgkmcnt(4)
    v_exp_f32 v147, v147
    v_mfma_f32_16x16x32_bf16 a[16:19], a[176:179], v[148:151], a[16:19]
    ds_read_b128 a[160:163], v3 offset:256
    v_cvt_pk_bf16_f32 v218, v144, v145
    v_mfma_f32_16x16x32_bf16 a[16:19], a[180:183], v[152:155], a[16:19]
    v_exp_f32 v108, v108
    v_mfma_f32_16x16x32_bf16 a[48:51], a[176:179], v[156:159], a[48:51]
    ds_read_b128 a[164:167], v3 offset:320
    v_cvt_pk_bf16_f32 v219, v146, v147
    v_mfma_f32_16x16x32_bf16 a[48:51], a[180:183], v[160:163], a[48:51]
    v_exp_f32 v109, v109
    v_mfma_f32_16x16x32_bf16 a[80:83], a[176:179], v[164:167], a[80:83]
    ds_read_b128 a[168:171], v4 offset:256
    v_cvt_pk_bf16_f32 v188, v108, v109
    v_mfma_f32_16x16x32_bf16 a[80:83], a[180:183], v[168:171], a[80:83]
    v_exp_f32 v110, v110
    v_mfma_f32_16x16x32_bf16 a[112:115], a[176:179], v[172:175], a[112:115]
    ds_read_b128 a[172:175], v4 offset:320
    v_mfma_f32_16x16x32_bf16 a[112:115], a[180:183], v[176:179], a[112:115]
    v_exp_f32 v111, v111
    v_mfma_f32_16x16x32_bf16 a[144:147], a[176:179], v[180:183], a[144:147]
    s_waitcnt lgkmcnt(4)
    v_cvt_pk_bf16_f32 v189, v110, v111
    v_mfma_f32_16x16x32_bf16 a[20:23], a[184:187], v[148:151], a[20:23]
    s_add_u32 m0, s35, 64
    v_exp_f32 v112, v112
    v_mfma_f32_16x16x32_bf16 a[20:23], a[188:191], v[152:155], a[20:23]
    buffer_load_dwordx4 v7, s[12:15], s69 offen offset:2048 nt lds
    v_mfma_f32_16x16x32_bf16 a[52:55], a[184:187], v[156:159], a[52:55]
    s_add_u32 m0, s35, 96
    v_exp_f32 v113, v113
    v_mfma_f32_16x16x32_bf16 a[52:55], a[188:191], v[160:163], a[52:55]
    buffer_load_dwordx4 v7, s[12:15], s69 offen offset:3072 nt lds
    v_mfma_f32_16x16x32_bf16 a[84:87], a[184:187], v[164:167], a[84:87]
    v_exp_f32 v114, v114
    v_mfma_f32_16x16x32_bf16 a[84:87], a[188:191], v[168:171], a[84:87]
    v_add_f32 v101, v101, v112
    v_cvt_pk_bf16_f32 v196, v112, v113
    v_mfma_f32_16x16x32_bf16 a[116:119], a[184:187], v[172:175], a[116:119]
    v_exp_f32 v115, v115
    v_mfma_f32_16x16x32_bf16 a[116:119], a[188:191], v[176:179], a[116:119]
    v_add_f32 v101, v101, v113
    v_add_f32 v101, v101, v114
    v_mfma_f32_16x16x32_bf16 a[148:151], a[184:187], v[180:183], a[148:151]
    s_waitcnt lgkmcnt(0)
    v_exp_f32 v116, v116
    v_mfma_f32_16x16x32_bf16 v[128:131], a[160:163], v[16:19], v[80:83]
    ds_read_b64_tr_b16 a[176:177], v5 offset:17088
    v_cvt_pk_bf16_f32 v197, v114, v115
    v_mfma_f32_16x16x32_bf16 v[128:131], a[164:167], v[20:23], v[128:131]
    v_exp_f32 v117, v117
    v_mfma_f32_16x16x32_bf16 v[128:131], a[168:171], v[24:27], v[128:131]
    ds_read_b64_tr_b16 a[178:179], v5 offset:17344
    v_add_f32 v101, v101, v115
    v_mfma_f32_16x16x32_bf16 v[128:131], a[172:175], v[28:31], v[128:131]
    s_add_u32 s39, s39, 16384
    v_exp_f32 v118, v118
    v_mfma_f32_16x16x32_bf16 v[132:135], a[160:163], v[32:35], v[84:87]
    ds_read_b64_tr_b16 a[180:181], v6 offset:17088
    v_add_f32 v102, v102, v116
    v_mfma_f32_16x16x32_bf16 v[132:135], a[164:167], v[36:39], v[132:135]
    s_xor_b32 s69, s39, s48
    v_exp_f32 v119, v119
    v_mfma_f32_16x16x32_bf16 v[132:135], a[168:171], v[40:43], v[132:135]
    ds_read_b64_tr_b16 a[182:183], v6 offset:17344
    v_cvt_pk_bf16_f32 v204, v116, v117
    v_mfma_f32_16x16x32_bf16 v[132:135], a[172:175], v[44:47], v[132:135]
    v_exp_f32 v120, v120
    v_mfma_f32_16x16x32_bf16 v[136:139], a[160:163], v[48:51], v[88:91]
    ds_read_b64_tr_b16 a[184:185], v5 offset:17120
    v_add_f32 v102, v102, v117
    v_mfma_f32_16x16x32_bf16 v[136:139], a[164:167], v[52:55], v[136:139]
    v_exp_f32 v121, v121
    v_mfma_f32_16x16x32_bf16 v[136:139], a[168:171], v[56:59], v[136:139]
    ds_read_b64_tr_b16 a[186:187], v5 offset:17376
    v_add_f32 v102, v102, v118
    v_mfma_f32_16x16x32_bf16 v[136:139], a[172:175], v[60:63], v[136:139]
    v_exp_f32 v122, v122
    v_mfma_f32_16x16x32_bf16 v[140:143], a[160:163], v[64:67], v[92:95]
    ds_read_b64_tr_b16 a[188:189], v6 offset:17120
    v_cvt_pk_bf16_f32 v205, v118, v119
    v_mfma_f32_16x16x32_bf16 v[140:143], a[164:167], v[68:71], v[140:143]
    v_exp_f32 v123, v123
    v_mfma_f32_16x16x32_bf16 v[140:143], a[168:171], v[72:75], v[140:143]
    ds_read_b64_tr_b16 a[190:191], v6 offset:17376
    v_add_f32 v102, v102, v119
    v_mfma_f32_16x16x32_bf16 v[140:143], a[172:175], v[76:79], v[140:143]
    v_exp_f32 v128, v128
    v_mfma_f32_16x16x32_bf16 a[240:243], v[252:255], v[180:183], a[240:243]
    s_waitcnt lgkmcnt(4)
    v_add_f32 v103, v103, v120
    v_cvt_pk_bf16_f32 v212, v120, v121
    v_mfma_f32_16x16x32_bf16 a[24:27], a[176:179], v[148:151], a[24:27]
    s_waitcnt vmcnt(8)
    v_exp_f32 v129, v129
    v_mfma_f32_16x16x32_bf16 a[24:27], a[180:183], v[152:155], a[24:27]
    s_barrier
    v_add_f32 v103, v103, v121
    v_add_f32 v103, v103, v122
    v_mfma_f32_16x16x32_bf16 a[56:59], a[176:179], v[156:159], a[56:59]
    ds_read_b128 a[160:163], v1 offset:33792
    v_cvt_pk_bf16_f32 v213, v122, v123
    v_mfma_f32_16x16x32_bf16 a[56:59], a[180:183], v[160:163], a[56:59]
    v_exp_f32 v130, v130
    v_mfma_f32_16x16x32_bf16 a[88:91], a[176:179], v[164:167], a[88:91]
    ds_read_b128 a[164:167], v1 offset:33856
    v_add_f32 v103, v103, v123
    v_mfma_f32_16x16x32_bf16 a[88:91], a[180:183], v[168:171], a[88:91]
    v_exp_f32 v131, v131
    v_mfma_f32_16x16x32_bf16 a[120:123], a[176:179], v[172:175], a[120:123]
    ds_read_b128 a[168:171], v2 offset:33792
    v_cvt_pk_bf16_f32 v190, v128, v129
    v_mfma_f32_16x16x32_bf16 a[120:123], a[180:183], v[176:179], a[120:123]
    v_exp_f32 v132, v132
    v_mfma_f32_16x16x32_bf16 a[152:155], a[176:179], v[180:183], a[152:155]
    s_waitcnt lgkmcnt(3)
    ds_read_b128 a[172:175], v2 offset:33856
    v_cvt_pk_bf16_f32 v191, v130, v131
    v_mfma_f32_16x16x32_bf16 a[28:31], a[184:187], v[148:151], a[28:31]
    s_add_u32 m0, s35, 50688
    v_exp_f32 v133, v133
    v_mfma_f32_16x16x32_bf16 a[28:31], a[188:191], v[152:155], a[28:31]
    buffer_load_dwordx4 v7, s[16:19], s49 offen offset:0 nt lds
    v_mfma_f32_16x16x32_bf16 a[60:63], a[184:187], v[156:159], a[60:63]
    s_add_u32 m0, s35, 50720
    v_exp_f32 v134, v134
    v_mfma_f32_16x16x32_bf16 a[60:63], a[188:191], v[160:163], a[60:63]
    buffer_load_dwordx4 v7, s[16:19], s49 offen offset:1024 nt lds
    v_mfma_f32_16x16x32_bf16 a[92:95], a[184:187], v[164:167], a[92:95]
    v_exp_f32 v135, v135
    v_mfma_f32_16x16x32_bf16 a[92:95], a[188:191], v[168:171], a[92:95]
    v_add_f32 v101, v101, v132
    v_cvt_pk_bf16_f32 v198, v132, v133
    v_mfma_f32_16x16x32_bf16 a[124:127], a[184:187], v[172:175], a[124:127]
    s_sub_u32 s33, s33, 1
    v_exp_f32 v136, v136
    v_mfma_f32_16x16x32_bf16 a[124:127], a[188:191], v[176:179], a[124:127]
    s_cmp_eq_u32 s33, 0
    v_add_f32 v101, v101, v133
    v_add_f32 v101, v101, v134
    v_mfma_f32_16x16x32_bf16 a[156:159], a[184:187], v[180:183], a[156:159]
    s_waitcnt lgkmcnt(0)
    v_exp_f32 v137, v137
    s_cbranch_scc1 K1_EPI
    v_mfma_f32_16x16x32_bf16 v[108:111], a[160:163], v[16:19], v[80:83]
    ds_read_b64_tr_b16 a[176:177], v5 offset:50688
    v_cvt_pk_bf16_f32 v199, v134, v135
    v_mfma_f32_16x16x32_bf16 v[108:111], a[164:167], v[20:23], v[108:111]
    v_exp_f32 v138, v138
    v_mfma_f32_16x16x32_bf16 v[108:111], a[168:171], v[24:27], v[108:111]
    ds_read_b64_tr_b16 a[178:179], v5 offset:50944
    v_add_f32 v101, v101, v135
    v_mfma_f32_16x16x32_bf16 v[108:111], a[172:175], v[28:31], v[108:111]
    v_exp_f32 v139, v139
    v_mfma_f32_16x16x32_bf16 v[112:115], a[160:163], v[32:35], v[84:87]
    ds_read_b64_tr_b16 a[180:181], v6 offset:50688
    v_add_f32 v102, v102, v136
    v_mfma_f32_16x16x32_bf16 v[112:115], a[164:167], v[36:39], v[112:115]
    v_exp_f32 v140, v140
    v_mfma_f32_16x16x32_bf16 v[112:115], a[168:171], v[40:43], v[112:115]
    ds_read_b64_tr_b16 a[182:183], v6 offset:50944
    v_cvt_pk_bf16_f32 v206, v136, v137
    v_mfma_f32_16x16x32_bf16 v[112:115], a[172:175], v[44:47], v[112:115]
    v_exp_f32 v141, v141
    v_mfma_f32_16x16x32_bf16 v[116:119], a[160:163], v[48:51], v[88:91]
    ds_read_b64_tr_b16 a[184:185], v5 offset:50720
    v_add_f32 v102, v102, v137
    v_mfma_f32_16x16x32_bf16 v[116:119], a[164:167], v[52:55], v[116:119]
    v_exp_f32 v142, v142
    v_mfma_f32_16x16x32_bf16 v[116:119], a[168:171], v[56:59], v[116:119]
    ds_read_b64_tr_b16 a[186:187], v5 offset:50976
    v_add_f32 v102, v102, v138
    v_mfma_f32_16x16x32_bf16 v[116:119], a[172:175], v[60:63], v[116:119]
    v_exp_f32 v143, v143
    v_mfma_f32_16x16x32_bf16 v[120:123], a[160:163], v[64:67], v[92:95]
    ds_read_b64_tr_b16 a[188:189], v6 offset:50720
    v_cvt_pk_bf16_f32 v207, v138, v139
    v_mfma_f32_16x16x32_bf16 v[120:123], a[164:167], v[68:71], v[120:123]
    v_exp_f32 v108, v108
    v_mfma_f32_16x16x32_bf16 v[120:123], a[168:171], v[72:75], v[120:123]
    ds_read_b64_tr_b16 a[190:191], v6 offset:50976
    v_add_f32 v102, v102, v139
    v_mfma_f32_16x16x32_bf16 v[120:123], a[172:175], v[76:79], v[120:123]
    v_exp_f32 v109, v109
    v_mfma_f32_16x16x32_bf16 v[124:127], a[160:163], a[192:195], v[96:99]
    v_add_f32 v103, v103, v140
    v_cvt_pk_bf16_f32 v214, v140, v141
    v_mfma_f32_16x16x32_bf16 v[124:127], a[164:167], a[196:199], v[124:127]
    v_exp_f32 v110, v110
    v_mfma_f32_16x16x32_bf16 v[124:127], a[168:171], a[200:203], v[124:127]
    v_add_f32 v103, v103, v141
    v_add_f32 v103, v103, v142
    v_mfma_f32_16x16x32_bf16 v[124:127], a[172:175], a[204:207], v[124:127]
    s_waitcnt lgkmcnt(4)
    v_exp_f32 v111, v111
    v_mfma_f32_16x16x32_bf16 a[0:3], a[176:179], v[184:187], a[0:3]
    ds_read_b128 a[160:163], v1 offset:34048
    v_cvt_pk_bf16_f32 v215, v142, v143
    v_mfma_f32_16x16x32_bf16 a[0:3], a[180:183], v[188:191], a[0:3]
    v_exp_f32 v112, v112
    v_mfma_f32_16x16x32_bf16 a[32:35], a[176:179], v[192:195], a[32:35]
    ds_read_b128 a[164:167], v1 offset:34112
    v_add_f32 v103, v103, v143
    v_mfma_f32_16x16x32_bf16 a[32:35], a[180:183], v[196:199], a[32:35]
    v_exp_f32 v113, v113
    v_mfma_f32_16x16x32_bf16 a[64:67], a[176:179], v[200:203], a[64:67]
    ds_read_b128 a[168:171], v2 offset:34048
    v_cvt_pk_bf16_f32 v148, v108, v109
    v_mfma_f32_16x16x32_bf16 a[64:67], a[180:183], v[204:207], a[64:67]
    v_exp_f32 v114, v114
    v_mfma_f32_16x16x32_bf16 a[96:99], a[176:179], v[208:211], a[96:99]
    ds_read_b128 a[172:175], v2 offset:34112
    v_cvt_pk_bf16_f32 v149, v110, v111
    v_mfma_f32_16x16x32_bf16 a[96:99], a[180:183], v[212:215], a[96:99]
    v_exp_f32 v115, v115
    v_mfma_f32_16x16x32_bf16 a[128:131], a[176:179], v[216:219], a[128:131]
    s_waitcnt lgkmcnt(4)
    v_add_f32 v101, v101, v112
    v_cvt_pk_bf16_f32 v156, v112, v113
    v_mfma_f32_16x16x32_bf16 a[4:7], a[184:187], v[184:187], a[4:7]
    s_add_u32 m0, s35, 50752
    v_exp_f32 v116, v116
    v_mfma_f32_16x16x32_bf16 a[4:7], a[188:191], v[188:191], a[4:7]
    buffer_load_dwordx4 v7, s[16:19], s49 offen offset:2048 nt lds
    v_mfma_f32_16x16x32_bf16 a[36:39], a[184:187], v[192:195], a[36:39]
    s_add_u32 m0, s35, 50784
    v_exp_f32 v117, v117
    v_mfma_f32_16x16x32_bf16 a[36:39], a[188:191], v[196:199], a[36:39]
    buffer_load_dwordx4 v7, s[16:19], s49 offen offset:3072 nt lds
    v_mfma_f32_16x16x32_bf16 a[68:71], a[184:187], v[200:203], a[68:71]
    v_exp_f32 v118, v118
    v_mfma_f32_16x16x32_bf16 a[68:71], a[188:191], v[204:207], a[68:71]
    v_add_f32 v101, v101, v113
    v_add_f32 v101, v101, v114
    v_mfma_f32_16x16x32_bf16 a[100:103], a[184:187], v[208:211], a[100:103]
    v_exp_f32 v119, v119
    v_mfma_f32_16x16x32_bf16 a[100:103], a[188:191], v[212:215], a[100:103]
    v_cvt_pk_bf16_f32 v157, v114, v115
    v_add_f32 v101, v101, v115
    v_mfma_f32_16x16x32_bf16 a[132:135], a[184:187], v[216:219], a[132:135]
    s_waitcnt lgkmcnt(0)
    v_exp_f32 v120, v120
    v_mfma_f32_16x16x32_bf16 v[128:131], a[160:163], v[16:19], v[80:83]
    ds_read_b64_tr_b16 a[176:177], v5 offset:50752
    v_add_f32 v102, v102, v116
    v_mfma_f32_16x16x32_bf16 v[128:131], a[164:167], v[20:23], v[128:131]
    v_exp_f32 v121, v121
    v_mfma_f32_16x16x32_bf16 v[128:131], a[168:171], v[24:27], v[128:131]
    ds_read_b64_tr_b16 a[178:179], v5 offset:51008
    v_cvt_pk_bf16_f32 v164, v116, v117
    v_mfma_f32_16x16x32_bf16 v[128:131], a[172:175], v[28:31], v[128:131]
    s_add_u32 s38, s38, 16384
    v_exp_f32 v122, v122
    v_mfma_f32_16x16x32_bf16 v[132:135], a[160:163], v[32:35], v[84:87]
    ds_read_b64_tr_b16 a[180:181], v6 offset:50752
    v_add_f32 v102, v102, v117
    v_mfma_f32_16x16x32_bf16 v[132:135], a[164:167], v[36:39], v[132:135]
    s_xor_b32 s49, s38, s48
    v_exp_f32 v123, v123
    v_mfma_f32_16x16x32_bf16 v[132:135], a[168:171], v[40:43], v[132:135]
    ds_read_b64_tr_b16 a[182:183], v6 offset:51008
    v_add_f32 v102, v102, v118
    v_mfma_f32_16x16x32_bf16 v[132:135], a[172:175], v[44:47], v[132:135]
    v_exp_f32 v124, v124
    v_mfma_f32_16x16x32_bf16 v[136:139], a[160:163], v[48:51], v[88:91]
    ds_read_b64_tr_b16 a[184:185], v5 offset:50784
    v_cvt_pk_bf16_f32 v165, v118, v119
    v_mfma_f32_16x16x32_bf16 v[136:139], a[164:167], v[52:55], v[136:139]
    v_exp_f32 v125, v125
    v_mfma_f32_16x16x32_bf16 v[136:139], a[168:171], v[56:59], v[136:139]
    ds_read_b64_tr_b16 a[186:187], v5 offset:51040
    v_add_f32 v102, v102, v119
    v_mfma_f32_16x16x32_bf16 v[136:139], a[172:175], v[60:63], v[136:139]
    v_exp_f32 v126, v126
    v_mfma_f32_16x16x32_bf16 v[140:143], a[160:163], v[64:67], v[92:95]
    ds_read_b64_tr_b16 a[188:189], v6 offset:50784
    v_add_f32 v103, v103, v120
    v_mfma_f32_16x16x32_bf16 v[140:143], a[164:167], v[68:71], v[140:143]
    v_exp_f32 v127, v127
    v_mfma_f32_16x16x32_bf16 v[140:143], a[168:171], v[72:75], v[140:143]
    ds_read_b64_tr_b16 a[190:191], v6 offset:51040
    v_cvt_pk_bf16_f32 v172, v120, v121
    v_mfma_f32_16x16x32_bf16 v[140:143], a[172:175], v[76:79], v[140:143]
    v_exp_f32 v128, v128
    v_mfma_f32_16x16x32_bf16 v[144:147], a[160:163], a[192:195], v[96:99]
    v_add_f32 v103, v103, v121
    v_add_f32 v103, v103, v122
    v_mfma_f32_16x16x32_bf16 v[144:147], a[164:167], a[196:199], v[144:147]
    v_exp_f32 v129, v129
    v_mfma_f32_16x16x32_bf16 v[144:147], a[168:171], a[200:203], v[144:147]
    v_cvt_pk_bf16_f32 v173, v122, v123
    v_add_f32 v103, v103, v123
    v_mfma_f32_16x16x32_bf16 v[144:147], a[172:175], a[204:207], v[144:147]
    s_waitcnt lgkmcnt(4)
    v_exp_f32 v130, v130
    v_mfma_f32_16x16x32_bf16 a[8:11], a[176:179], v[184:187], a[8:11]
    ds_read_b128 a[160:163], v3 offset:33792
    v_cvt_pk_bf16_f32 v180, v124, v125
    v_mfma_f32_16x16x32_bf16 a[8:11], a[180:183], v[188:191], a[8:11]
    v_exp_f32 v131, v131
    v_mfma_f32_16x16x32_bf16 a[40:43], a[176:179], v[192:195], a[40:43]
    ds_read_b128 a[164:167], v3 offset:33856
    v_cvt_pk_bf16_f32 v181, v126, v127
    v_mfma_f32_16x16x32_bf16 a[40:43], a[180:183], v[196:199], a[40:43]
    v_exp_f32 v132, v132
    v_mfma_f32_16x16x32_bf16 a[72:75], a[176:179], v[200:203], a[72:75]
    ds_read_b128 a[168:171], v4 offset:33792
    v_cvt_pk_bf16_f32 v150, v128, v129
    v_mfma_f32_16x16x32_bf16 a[72:75], a[180:183], v[204:207], a[72:75]
    v_exp_f32 v133, v133
    v_mfma_f32_16x16x32_bf16 a[104:107], a[176:179], v[208:211], a[104:107]
    ds_read_b128 a[172:175], v4 offset:33856
    v_cvt_pk_bf16_f32 v151, v130, v131
    v_mfma_f32_16x16x32_bf16 a[104:107], a[180:183], v[212:215], a[104:107]
    v_exp_f32 v134, v134
    v_mfma_f32_16x16x32_bf16 a[136:139], a[176:179], v[216:219], a[136:139]
    s_waitcnt lgkmcnt(4)
    v_add_f32 v101, v101, v132
    v_cvt_pk_bf16_f32 v158, v132, v133
    v_mfma_f32_16x16x32_bf16 a[12:15], a[184:187], v[184:187], a[12:15]
    s_add_u32 m0, s35, 33792
    v_exp_f32 v135, v135
    v_mfma_f32_16x16x32_bf16 a[12:15], a[188:191], v[188:191], a[12:15]
    buffer_load_dwordx4 v7, s[12:15], s69 offen offset:0 nt lds
    v_mfma_f32_16x16x32_bf16 a[44:47], a[184:187], v[192:195], a[44:47]
    s_add_u32 m0, s35, 33824
    v_exp_f32 v136, v136
    v_mfma_f32_16x16x32_bf16 a[44:47], a[188:191], v[196:199], a[44:47]
    buffer_load_dwordx4 v7, s[12:15], s69 offen offset:1024 nt lds
    v_mfma_f32_16x16x32_bf16 a[76:79], a[184:187], v[200:203], a[76:79]
    v_exp_f32 v137, v137
    v_mfma_f32_16x16x32_bf16 a[76:79], a[188:191], v[204:207], a[76:79]
    v_add_f32 v101, v101, v133
    v_add_f32 v101, v101, v134
    v_mfma_f32_16x16x32_bf16 a[108:111], a[184:187], v[208:211], a[108:111]
    v_cvt_pk_bf16_f32 v159, v134, v135
    v_add_f32 v101, v101, v135
    v_mfma_f32_16x16x32_bf16 a[108:111], a[188:191], v[212:215], a[108:111]
    v_add_f32 v102, v102, v136
    v_cvt_pk_bf16_f32 v166, v136, v137
    v_mfma_f32_16x16x32_bf16 a[140:143], a[184:187], v[216:219], a[140:143]
    s_waitcnt lgkmcnt(0)
    v_exp_f32 v138, v138
    v_mfma_f32_16x16x32_bf16 v[108:111], a[160:163], v[16:19], v[80:83]
    ds_read_b64_tr_b16 a[176:177], v5 offset:50816
    v_add_f32 v102, v102, v137
    v_mfma_f32_16x16x32_bf16 v[108:111], a[164:167], v[20:23], v[108:111]
    v_exp_f32 v139, v139
    v_mfma_f32_16x16x32_bf16 v[108:111], a[168:171], v[24:27], v[108:111]
    ds_read_b64_tr_b16 a[178:179], v5 offset:51072
    v_add_f32 v102, v102, v138
    v_mfma_f32_16x16x32_bf16 v[108:111], a[172:175], v[28:31], v[108:111]
    s_sub_u32 s37, s35, s34
    v_exp_f32 v140, v140
    v_mfma_f32_16x16x32_bf16 v[112:115], a[160:163], v[32:35], v[84:87]
    ds_read_b64_tr_b16 a[180:181], v6 offset:50816
    v_cvt_pk_bf16_f32 v167, v138, v139
    v_mfma_f32_16x16x32_bf16 v[112:115], a[164:167], v[36:39], v[112:115]
    v_exp_f32 v141, v141
    v_mfma_f32_16x16x32_bf16 v[112:115], a[168:171], v[40:43], v[112:115]
    ds_read_b64_tr_b16 a[182:183], v6 offset:51072
    v_add_f32 v102, v102, v139
    v_mfma_f32_16x16x32_bf16 v[112:115], a[172:175], v[44:47], v[112:115]
    v_exp_f32 v142, v142
    v_mfma_f32_16x16x32_bf16 v[116:119], a[160:163], v[48:51], v[88:91]
    ds_read_b64_tr_b16 a[184:185], v5 offset:50848
    v_add_f32 v103, v103, v140
    v_mfma_f32_16x16x32_bf16 v[116:119], a[164:167], v[52:55], v[116:119]
    v_exp_f32 v143, v143
    v_mfma_f32_16x16x32_bf16 v[116:119], a[168:171], v[56:59], v[116:119]
    ds_read_b64_tr_b16 a[186:187], v5 offset:51104
    v_cvt_pk_bf16_f32 v174, v140, v141
    v_mfma_f32_16x16x32_bf16 v[116:119], a[172:175], v[60:63], v[116:119]
    v_exp_f32 v144, v144
    v_mfma_f32_16x16x32_bf16 v[120:123], a[160:163], v[64:67], v[92:95]
    ds_read_b64_tr_b16 a[188:189], v6 offset:50848
    v_add_f32 v103, v103, v141
    v_mfma_f32_16x16x32_bf16 v[120:123], a[164:167], v[68:71], v[120:123]
    v_exp_f32 v145, v145
    v_mfma_f32_16x16x32_bf16 v[120:123], a[168:171], v[72:75], v[120:123]
    ds_read_b64_tr_b16 a[190:191], v6 offset:51104
    v_add_f32 v103, v103, v142
    v_mfma_f32_16x16x32_bf16 v[120:123], a[172:175], v[76:79], v[120:123]
    v_exp_f32 v146, v146
    v_mfma_f32_16x16x32_bf16 a[236:239], v[252:255], v[184:187], a[236:239]
    v_cvt_pk_bf16_f32 v175, v142, v143
    v_add_f32 v103, v103, v143
    v_mfma_f32_16x16x32_bf16 a[236:239], v[252:255], v[188:191], a[236:239]
    s_waitcnt lgkmcnt(4)
    v_exp_f32 v147, v147
    v_mfma_f32_16x16x32_bf16 a[16:19], a[176:179], v[184:187], a[16:19]
    ds_read_b128 a[160:163], v3 offset:34048
    v_cvt_pk_bf16_f32 v182, v144, v145
    v_mfma_f32_16x16x32_bf16 a[16:19], a[180:183], v[188:191], a[16:19]
    v_exp_f32 v108, v108
    v_mfma_f32_16x16x32_bf16 a[48:51], a[176:179], v[192:195], a[48:51]
    ds_read_b128 a[164:167], v3 offset:34112
    v_cvt_pk_bf16_f32 v183, v146, v147
    v_mfma_f32_16x16x32_bf16 a[48:51], a[180:183], v[196:199], a[48:51]
    v_exp_f32 v109, v109
    v_mfma_f32_16x16x32_bf16 a[80:83], a[176:179], v[200:203], a[80:83]
    ds_read_b128 a[168:171], v4 offset:34048
    v_cvt_pk_bf16_f32 v152, v108, v109
    v_mfma_f32_16x16x32_bf16 a[80:83], a[180:183], v[204:207], a[80:83]
    v_exp_f32 v110, v110
    v_mfma_f32_16x16x32_bf16 a[112:115], a[176:179], v[208:211], a[112:115]
    ds_read_b128 a[172:175], v4 offset:34112
    v_mfma_f32_16x16x32_bf16 a[112:115], a[180:183], v[212:215], a[112:115]
    v_exp_f32 v111, v111
    v_add_u32 v2, s37, v2
    v_mfma_f32_16x16x32_bf16 a[144:147], a[176:179], v[216:219], a[144:147]
    s_waitcnt lgkmcnt(4)
    v_cvt_pk_bf16_f32 v153, v110, v111
    v_add_u32 v1, s37, v1
    v_add_u32 v3, s37, v3
    v_mfma_f32_16x16x32_bf16 a[20:23], a[184:187], v[184:187], a[20:23]
    s_add_u32 m0, s35, 33856
    v_exp_f32 v112, v112
    v_add_u32 v4, s37, v4
    v_mfma_f32_16x16x32_bf16 a[20:23], a[188:191], v[188:191], a[20:23]
    buffer_load_dwordx4 v7, s[12:15], s69 offen offset:2048 nt lds
    v_mfma_f32_16x16x32_bf16 a[52:55], a[184:187], v[192:195], a[52:55]
    s_add_u32 m0, s35, 33888
    v_exp_f32 v113, v113
    v_mfma_f32_16x16x32_bf16 a[52:55], a[188:191], v[196:199], a[52:55]
    buffer_load_dwordx4 v7, s[12:15], s69 offen offset:3072 nt lds
    v_mfma_f32_16x16x32_bf16 a[84:87], a[184:187], v[200:203], a[84:87]
    v_exp_f32 v114, v114
    v_mfma_f32_16x16x32_bf16 a[84:87], a[188:191], v[204:207], a[84:87]
    v_add_f32 v101, v101, v112
    v_cvt_pk_bf16_f32 v160, v112, v113
    v_mfma_f32_16x16x32_bf16 a[116:119], a[184:187], v[208:211], a[116:119]
    v_exp_f32 v115, v115
    v_mfma_f32_16x16x32_bf16 a[116:119], a[188:191], v[212:215], a[116:119]
    v_add_f32 v101, v101, v113
    v_add_f32 v101, v101, v114
    v_mfma_f32_16x16x32_bf16 a[148:151], a[184:187], v[216:219], a[148:151]
    s_waitcnt lgkmcnt(0)
    v_exp_f32 v116, v116
    v_mfma_f32_16x16x32_bf16 v[128:131], a[160:163], v[16:19], v[80:83]
    ds_read_b64_tr_b16 a[176:177], v5 offset:50880
    v_cvt_pk_bf16_f32 v161, v114, v115
    v_mfma_f32_16x16x32_bf16 v[128:131], a[164:167], v[20:23], v[128:131]
    v_exp_f32 v117, v117
    v_mfma_f32_16x16x32_bf16 v[128:131], a[168:171], v[24:27], v[128:131]
    ds_read_b64_tr_b16 a[178:179], v5 offset:51136
    v_add_f32 v101, v101, v115
    v_mfma_f32_16x16x32_bf16 v[128:131], a[172:175], v[28:31], v[128:131]
    s_add_u32 s39, s39, 16384
    v_exp_f32 v118, v118
    v_mfma_f32_16x16x32_bf16 v[132:135], a[160:163], v[32:35], v[84:87]
    ds_read_b64_tr_b16 a[180:181], v6 offset:50880
    v_add_f32 v102, v102, v116
    v_mfma_f32_16x16x32_bf16 v[132:135], a[164:167], v[36:39], v[132:135]
    s_xor_b32 s69, s39, s48
    v_exp_f32 v119, v119
    v_mfma_f32_16x16x32_bf16 v[132:135], a[168:171], v[40:43], v[132:135]
    ds_read_b64_tr_b16 a[182:183], v6 offset:51136
    v_cvt_pk_bf16_f32 v168, v116, v117
    v_mfma_f32_16x16x32_bf16 v[132:135], a[172:175], v[44:47], v[132:135]
    v_exp_f32 v120, v120
    v_mfma_f32_16x16x32_bf16 v[136:139], a[160:163], v[48:51], v[88:91]
    ds_read_b64_tr_b16 a[184:185], v5 offset:50912
    v_add_f32 v102, v102, v117
    v_mfma_f32_16x16x32_bf16 v[136:139], a[164:167], v[52:55], v[136:139]
    s_cmp_eq_u32 s33, 1
    v_exp_f32 v121, v121
    v_mfma_f32_16x16x32_bf16 v[136:139], a[168:171], v[56:59], v[136:139]
    s_cselect_b32 s44, 0, 0x40000000
    ds_read_b64_tr_b16 a[186:187], v5 offset:51168
    v_add_f32 v102, v102, v118
    v_mfma_f32_16x16x32_bf16 v[136:139], a[172:175], v[60:63], v[136:139]
    s_cselect_b32 s45, s46, 0x40000000
    v_exp_f32 v122, v122
    v_mfma_f32_16x16x32_bf16 v[140:143], a[160:163], v[64:67], v[92:95]
    ds_read_b64_tr_b16 a[188:189], v6 offset:50912
    v_cvt_pk_bf16_f32 v169, v118, v119
    v_mfma_f32_16x16x32_bf16 v[140:143], a[164:167], v[68:71], v[140:143]
    v_exp_f32 v123, v123
    v_mfma_f32_16x16x32_bf16 v[140:143], a[168:171], v[72:75], v[140:143]
    ds_read_b64_tr_b16 a[190:191], v6 offset:51168
    v_add_f32 v102, v102, v119
    v_mfma_f32_16x16x32_bf16 v[140:143], a[172:175], v[76:79], v[140:143]
    v_exp_f32 v128, v128
    v_add_u32 v5, s37, v5
    v_mfma_f32_16x16x32_bf16 a[240:243], v[252:255], v[216:219], a[240:243]
    s_waitcnt lgkmcnt(4)
    v_add_f32 v103, v103, v120
    v_cvt_pk_bf16_f32 v176, v120, v121
    v_add_u32 v6, s37, v6
    v_mfma_f32_16x16x32_bf16 a[24:27], a[176:179], v[184:187], a[24:27]
    s_waitcnt vmcnt(8)
    v_exp_f32 v129, v129
    v_mfma_f32_16x16x32_bf16 a[24:27], a[180:183], v[188:191], a[24:27]
    s_barrier
    v_add_f32 v103, v103, v121
    v_add_f32 v103, v103, v122
    buffer_load_dword v106, v105, s[40:43], s44 offen
    v_mfma_f32_16x16x32_bf16 a[56:59], a[176:179], v[192:195], a[56:59]
    ds_read_b128 a[160:163], v1 offset:0
    v_cvt_pk_bf16_f32 v177, v122, v123
    buffer_load_dword v106, v105, s[40:43], s45 offen
    v_mfma_f32_16x16x32_bf16 a[56:59], a[180:183], v[196:199], a[56:59]
    v_exp_f32 v130, v130
    v_mfma_f32_16x16x32_bf16 a[88:91], a[176:179], v[200:203], a[88:91]
    ds_read_b128 a[164:167], v1 offset:64
    v_add_f32 v103, v103, v123
    v_mfma_f32_16x16x32_bf16 a[88:91], a[180:183], v[204:207], a[88:91]
    v_exp_f32 v131, v131
    v_mfma_f32_16x16x32_bf16 a[120:123], a[176:179], v[208:211], a[120:123]
    ds_read_b128 a[168:171], v2 offset:0
    v_cvt_pk_bf16_f32 v154, v128, v129
    v_mfma_f32_16x16x32_bf16 a[120:123], a[180:183], v[212:215], a[120:123]
    v_exp_f32 v132, v132
    v_mfma_f32_16x16x32_bf16 a[152:155], a[176:179], v[216:219], a[152:155]
    s_waitcnt lgkmcnt(3)
    ds_read_b128 a[172:175], v2 offset:64
    v_cvt_pk_bf16_f32 v155, v130, v131
    v_mfma_f32_16x16x32_bf16 a[28:31], a[184:187], v[184:187], a[28:31]
    s_add_u32 m0, s34, 16896
    v_exp_f32 v133, v133
    v_mfma_f32_16x16x32_bf16 a[28:31], a[188:191], v[188:191], a[28:31]
    buffer_load_dwordx4 v7, s[16:19], s49 offen offset:0 nt lds
    v_mfma_f32_16x16x32_bf16 a[60:63], a[184:187], v[192:195], a[60:63]
    s_add_u32 m0, s34, 16928
    v_exp_f32 v134, v134
    v_mfma_f32_16x16x32_bf16 a[60:63], a[188:191], v[196:199], a[60:63]
    buffer_load_dwordx4 v7, s[16:19], s49 offen offset:1024 nt lds
    v_mfma_f32_16x16x32_bf16 a[92:95], a[184:187], v[200:203], a[92:95]
    v_exp_f32 v135, v135
    v_mfma_f32_16x16x32_bf16 a[92:95], a[188:191], v[204:207], a[92:95]
    s_xor_b32 s34, s34, s36
    v_add_f32 v101, v101, v132
    v_cvt_pk_bf16_f32 v162, v132, v133
    v_mfma_f32_16x16x32_bf16 a[124:127], a[184:187], v[208:211], a[124:127]
    s_xor_b32 s35, s35, s36
    v_exp_f32 v136, v136
    v_mfma_f32_16x16x32_bf16 a[124:127], a[188:191], v[212:215], a[124:127]
    v_add_f32 v101, v101, v133
    v_add_f32 v101, v101, v134
    v_mfma_f32_16x16x32_bf16 a[156:159], a[184:187], v[216:219], a[156:159]
    s_waitcnt lgkmcnt(0)
    v_exp_f32 v137, v137
    s_branch K1_ALOOP
K1_EPI:
    ds_read_b64_tr_b16 a[160:161], v5 offset:50688
    ds_read_b64_tr_b16 a[162:163], v5 offset:50944
    ds_read_b64_tr_b16 a[164:165], v6 offset:50688
    ds_read_b64_tr_b16 a[166:167], v6 offset:50944
    ds_read_b64_tr_b16 a[168:169], v5 offset:50720
    ds_read_b64_tr_b16 a[170:171], v5 offset:50976
    ds_read_b64_tr_b16 a[172:173], v6 offset:50720
    ds_read_b64_tr_b16 a[174:175], v6 offset:50976
    v_exp_f32 v138, v138
    v_exp_f32 v139, v139
    v_cvt_pk_bf16_f32 v199, v134, v135
    v_exp_f32 v140, v140
    v_exp_f32 v141, v141
    v_exp_f32 v142, v142
    v_cvt_pk_bf16_f32 v206, v136, v137
    v_exp_f32 v143, v143
    v_cvt_pk_bf16_f32 v207, v138, v139
    v_cvt_pk_bf16_f32 v214, v140, v141
    v_cvt_pk_bf16_f32 v215, v142, v143
    ds_read_b64_tr_b16 a[176:177], v5 offset:50752
    ds_read_b64_tr_b16 a[178:179], v5 offset:51008
    ds_read_b64_tr_b16 a[180:181], v6 offset:50752
    ds_read_b64_tr_b16 a[182:183], v6 offset:51008
    ds_read_b64_tr_b16 a[184:185], v5 offset:50784
    ds_read_b64_tr_b16 a[186:187], v5 offset:51040
    ds_read_b64_tr_b16 a[188:189], v6 offset:50784
    ds_read_b64_tr_b16 a[190:191], v6 offset:51040
    s_getpc_b64 s[8:9]
K1_PC:
    s_add_u32 s8, s8, K2_END-8192-K1_PC
    s_addc_u32 s9, s9, 0
    global_load_dword v106, v105, s[8:9]
    v_lshrrev_b32 v9, 3, v0
    v_mul_u32_u24 v9, 4608, v9
    v_and_b32 v10, 7, v0
    v_lshl_add_u32 v9, v10, 4, v9
    s_mul_i32 s63, s24, 36864
    s_mov_b32 s31, 0
    s_mov_b32 s32, 147456
    v_add_u32 v80, s63, v9
    v_add_u32 v81, 96, v80
    v_add_u32 v82, 192, v80
    v_add_u32 v83, 288, v80
    s_waitcnt lgkmcnt(12)
    s_add_u32 m0, s67, 0
    v_mfma_f32_16x16x32_bf16 a[0:3], a[160:163], v[184:187], a[0:3]
    buffer_load_dwordx4 v80, s[56:59], s31 offen offset:0 lds
    v_mfma_f32_16x16x32_bf16 a[0:3], a[164:167], v[188:191], a[0:3]
    v_add_f32 v101, v101, v135
    v_add_f32 v102, v102, v136
    v_mfma_f32_16x16x32_bf16 a[32:35], a[160:163], v[192:195], a[32:35]
    buffer_load_dwordx4 v81, s[56:59], s31 offen offset:1056 lds
    v_mfma_f32_16x16x32_bf16 a[32:35], a[164:167], v[196:199], a[32:35]
    v_add_f32 v102, v102, v137
    v_add_f32 v102, v102, v138
    v_mfma_f32_16x16x32_bf16 a[64:67], a[160:163], v[200:203], a[64:67]
    buffer_load_dwordx4 v82, s[56:59], s31 offen offset:2112 lds
    v_mfma_f32_16x16x32_bf16 a[64:67], a[164:167], v[204:207], a[64:67]
    v_add_f32 v102, v102, v139
    v_add_f32 v103, v103, v140
    v_mfma_f32_16x16x32_bf16 a[96:99], a[160:163], v[208:211], a[96:99]
    buffer_load_dwordx4 v83, s[56:59], s31 offen offset:3168 lds
    v_mfma_f32_16x16x32_bf16 a[96:99], a[164:167], v[212:215], a[96:99]
    s_add_u32 m0, s67, 16896
    v_add_f32 v103, v103, v141
    v_add_f32 v103, v103, v142
    v_mfma_f32_16x16x32_bf16 a[128:131], a[160:163], v[216:219], a[128:131]
    buffer_load_dwordx4 v80, s[56:59], s32 offen offset:0 lds
    v_mfma_f32_16x16x32_bf16 a[236:239], v[252:255], v[184:187], a[236:239]
    ds_read_b64_tr_b16 a[160:161], v5 offset:50816
    v_add_f32 v103, v103, v143
    s_xor_b32 s63, s24, 2
    s_mul_i32 s63, s63, 4224
    s_add_u32 s63, s63, 67584
    s_add_u32 s64, s67, 67584
    v_mfma_f32_16x16x32_bf16 a[236:239], v[252:255], v[188:191], a[236:239]
    ds_read_b64_tr_b16 a[162:163], v5 offset:51072
    v_add_u32 v92, s63, v8
    v_mfma_f32_16x16x32_bf16 a[240:243], v[252:255], v[216:219], a[240:243]
    s_waitcnt lgkmcnt(10)
    ds_read_b64_tr_b16 a[164:165], v6 offset:50816
    v_add_u32 v93, s64, v8
    v_mfma_f32_16x16x32_bf16 a[4:7], a[168:171], v[184:187], a[4:7]
    ds_read_b64_tr_b16 a[166:167], v6 offset:51072
    v_mfma_f32_16x16x32_bf16 a[4:7], a[172:175], v[188:191], a[4:7]
    buffer_load_dwordx4 v81, s[56:59], s32 offen offset:1056 lds
    v_mfma_f32_16x16x32_bf16 a[36:39], a[168:171], v[192:195], a[36:39]
    v_mfma_f32_16x16x32_bf16 a[36:39], a[172:175], v[196:199], a[36:39]
    buffer_load_dwordx4 v82, s[56:59], s32 offen offset:2112 lds
    v_mfma_f32_16x16x32_bf16 a[68:71], a[168:171], v[200:203], a[68:71]
    v_accvgpr_read_b32 v100, a236
    v_mov_b32 v9, v101
    v_mfma_f32_16x16x32_bf16 a[68:71], a[172:175], v[204:207], a[68:71]
    buffer_load_dwordx4 v83, s[56:59], s32 offen offset:3168 lds
    v_mfma_f32_16x16x32_bf16 a[100:103], a[168:171], v[208:211], a[100:103]
    s_add_u32 s31, s31, 128
    s_add_u32 s32, s32, 128
    s_add_u32 m0, s67, 33792
    v_permlane32_swap_b32 v101, v9
    v_add_f32 v101, v101, v9
    v_mfma_f32_16x16x32_bf16 a[100:103], a[172:175], v[212:215], a[100:103]
    buffer_load_dwordx4 v80, s[56:59], s31 offen offset:0 lds
    v_mfma_f32_16x16x32_bf16 a[132:135], a[168:171], v[216:219], a[132:135]
    s_waitcnt lgkmcnt(8)
    v_mov_b32 v9, v101
    s_nop 1
    v_permlane16_swap_b32 v101, v9
    v_mfma_f32_16x16x32_bf16 a[8:11], a[176:179], v[184:187], a[8:11]
    ds_read_b64_tr_b16 a[168:169], v5 offset:50848
    v_add_f32 v101, v101, v9
    v_mfma_f32_16x16x32_bf16 a[8:11], a[180:183], v[188:191], a[8:11]
    ds_read_b64_tr_b16 a[170:171], v5 offset:51104
    v_mov_b32 v9, v102
    v_mfma_f32_16x16x32_bf16 a[40:43], a[176:179], v[192:195], a[40:43]
    ds_read_b64_tr_b16 a[172:173], v6 offset:50848
    v_permlane32_swap_b32 v102, v9
    v_mfma_f32_16x16x32_bf16 a[40:43], a[180:183], v[196:199], a[40:43]
    ds_read_b64_tr_b16 a[174:175], v6 offset:51104
    v_add_f32 v102, v102, v9
    v_mfma_f32_16x16x32_bf16 a[72:75], a[176:179], v[200:203], a[72:75]
    buffer_load_dwordx4 v81, s[56:59], s31 offen offset:1056 lds
    v_mfma_f32_16x16x32_bf16 a[72:75], a[180:183], v[204:207], a[72:75]
    v_mov_b32 v9, v102
    s_nop 1
    v_permlane16_swap_b32 v102, v9
    v_mfma_f32_16x16x32_bf16 a[104:107], a[176:179], v[208:211], a[104:107]
    buffer_load_dwordx4 v82, s[56:59], s31 offen offset:2112 lds
    v_mfma_f32_16x16x32_bf16 a[104:107], a[180:183], v[212:215], a[104:107]
    v_add_f32 v102, v102, v9
    v_mov_b32 v9, v103
    v_mfma_f32_16x16x32_bf16 a[136:139], a[176:179], v[216:219], a[136:139]
    s_waitcnt lgkmcnt(8)
    buffer_load_dwordx4 v83, s[56:59], s31 offen offset:3168 lds
    v_mfma_f32_16x16x32_bf16 a[12:15], a[184:187], v[184:187], a[12:15]
    ds_read_b64_tr_b16 a[176:177], v5 offset:50880
    v_permlane32_swap_b32 v103, v9
    v_mfma_f32_16x16x32_bf16 a[12:15], a[188:191], v[188:191], a[12:15]
    ds_read_b64_tr_b16 a[178:179], v5 offset:51136
    v_add_f32 v103, v103, v9
    v_mfma_f32_16x16x32_bf16 a[44:47], a[184:187], v[192:195], a[44:47]
    ds_read_b64_tr_b16 a[180:181], v6 offset:50880
    v_mov_b32 v9, v103
    v_mfma_f32_16x16x32_bf16 a[44:47], a[188:191], v[196:199], a[44:47]
    s_add_u32 m0, s67, 50688
    ds_read_b64_tr_b16 a[182:183], v6 offset:51136
    v_permlane16_swap_b32 v103, v9
    v_mfma_f32_16x16x32_bf16 a[76:79], a[184:187], v[200:203], a[76:79]
    buffer_load_dwordx4 v80, s[56:59], s32 offen offset:0 lds
    v_mfma_f32_16x16x32_bf16 a[76:79], a[188:191], v[204:207], a[76:79]
    v_add_f32 v103, v103, v9
    v_accvgpr_read_b32 v104, a240
    v_mfma_f32_16x16x32_bf16 a[108:111], a[184:187], v[208:211], a[108:111]
    buffer_load_dwordx4 v81, s[56:59], s32 offen offset:1056 lds
    v_mfma_f32_16x16x32_bf16 a[108:111], a[188:191], v[212:215], a[108:111]
    v_add_f32 v9, v100, v101
    v_add_f32 v10, v102, v103
    v_mfma_f32_16x16x32_bf16 a[140:143], a[184:187], v[216:219], a[140:143]
    s_waitcnt lgkmcnt(8)
    buffer_load_dwordx4 v82, s[56:59], s32 offen offset:2112 lds
    v_mfma_f32_16x16x32_bf16 a[16:19], a[160:163], v[184:187], a[16:19]
    ds_read_b64_tr_b16 a[184:185], v5 offset:50912
    v_rcp_f32 v100, v100
    v_mfma_f32_16x16x32_bf16 a[16:19], a[164:167], v[188:191], a[16:19]
    ds_read_b64_tr_b16 a[186:187], v5 offset:51168
    v_add_f32 v9, v9, v104
    v_mfma_f32_16x16x32_bf16 a[48:51], a[160:163], v[192:195], a[48:51]
    ds_read_b64_tr_b16 a[188:189], v6 offset:50912
    v_rcp_f32 v101, v101
    v_mfma_f32_16x16x32_bf16 a[48:51], a[164:167], v[196:199], a[48:51]
    ds_read_b64_tr_b16 a[190:191], v6 offset:51168
    v_add_f32 v9, v9, v10
    v_mfma_f32_16x16x32_bf16 a[80:83], a[160:163], v[200:203], a[80:83]
    buffer_load_dwordx4 v83, s[56:59], s32 offen offset:3168 lds
    v_mfma_f32_16x16x32_bf16 a[80:83], a[164:167], v[204:207], a[80:83]
    s_add_u32 s31, s31, 128
    s_add_u32 s32, s32, 128
    v_rcp_f32 v102, v102
    v_mfma_f32_16x16x32_bf16 a[112:115], a[160:163], v[208:211], a[112:115]
    v_mov_b32 v10, 0x4e800000
    v_rcp_f32 v103, v103
    v_mfma_f32_16x16x32_bf16 a[112:115], a[164:167], v[212:215], a[112:115]
    v_cmp_nlt_f32 vcc, v9, v10
    s_nop 0
    s_cmp_lg_u64 vcc, 0
    s_cselect_b32 s65, s62, 0
    v_mov_b32 v9, s65
    s_lshl_b32 s63, s24, 8
    s_xor_b32 s64, s63, 256
    s_add_u32 s63, s63, 160320
    s_add_u32 s64, s64, 160320
    v_mfma_f32_16x16x32_bf16 a[144:147], a[160:163], v[216:219], a[144:147]
    s_waitcnt lgkmcnt(8)
    v_lshlrev_b32 v10, 2, v0
    v_add_u32 v13, s63, v10
    v_mfma_f32_16x16x32_bf16 a[20:23], a[168:171], v[184:187], a[20:23]
    v_add_u32 v14, s64, v10
    s_lshl_b32 s63, s24, 2
    s_add_u32 s63, s63, 160256
    v_mov_b32 v15, s63
    v_mfma_f32_16x16x32_bf16 a[20:23], a[172:175], v[188:191], a[20:23]
    ds_write_b32 v13, v104
    ds_write_b32 v15, v9
    s_lshl_b32 s63, s24, 12
    s_xor_b32 s64, s63, 4096
    s_add_u32 s63, s63, 135168
    s_add_u32 s64, s64, 135168
    v_mfma_f32_16x16x32_bf16 a[52:55], a[168:171], v[192:195], a[52:55]
    s_waitcnt lgkmcnt(2)
    v_add_u32 v94, s63, v8
    v_add_u32 v95, s64, v8
    s_lshl_b32 s63, s24, 11
    s_add_u32 s63, s63, 152064
    v_mfma_f32_16x16x32_bf16 a[52:55], a[172:175], v[196:199], a[52:55]
    s_barrier
    v_add_u32 v96, s63, v8
    s_lshl_b32 s63, s26, 12
    s_xor_b32 s64, s63, 4096
    s_add_u32 s63, s63, 152064
    s_add_u32 s64, s64, 152064
    v_add_u32 v97, s63, v8
    v_mfma_f32_16x16x32_bf16 a[84:87], a[168:171], v[200:203], a[84:87]
    v_add_u32 v98, s64, v8
    s_mul_i32 s63, s24, 3584
    s_sub_u32 s63, 147456, s63
    v_lshlrev_b32 v10, 3, v0
    v_mfma_f32_16x16x32_bf16 a[84:87], a[172:175], v[204:207], a[84:87]
    v_add_u32 v99, s63, v10
    v_bfe_u32 v10, v0, 2, 2
    v_mfma_f32_16x16x32_bf16 a[116:119], a[168:171], v[208:211], a[116:119]
    v_mul_u32_u24 v10, 1056, v10
    v_lshrrev_b32 v11, 4, v0
    v_mfma_f32_16x16x32_bf16 a[116:119], a[172:175], v[212:215], a[116:119]
    v_lshl_add_u32 v10, v11, 7, v10
    v_and_b32 v11, 3, v0
    v_mfma_f32_16x16x32_bf16 a[148:151], a[168:171], v[216:219], a[148:151]
    v_lshl_add_u32 v10, v11, 3, v10
    s_lshl_b32 s63, s24, 5
    s_xor_b32 s64, s63, 32
    s_mul_i32 s65, s26, 16896
    s_sub_u32 s66, 16896, s65
    v_add_u32 v11, s64, v10
    v_mfma_f32_16x16x32_bf16 a[24:27], a[176:179], v[184:187], a[24:27]
    v_add_u32 v10, s63, v10
    v_add_u32 v84, s65, v11
    v_mfma_f32_16x16x32_bf16 a[24:27], a[180:183], v[188:191], a[24:27]
    v_add_u32 v85, s66, v11
    v_add_u32 v86, s65, v10
    v_mfma_f32_16x16x32_bf16 a[56:59], a[176:179], v[192:195], a[56:59]
    v_add_u32 v87, s66, v10
    v_mov_b32 v88, v84
    v_mfma_f32_16x16x32_bf16 a[56:59], a[180:183], v[196:199], a[56:59]
    v_mov_b32 v89, v85
    v_mov_b32 v90, v86
    v_mfma_f32_16x16x32_bf16 a[88:91], a[176:179], v[200:203], a[88:91]
    v_mov_b32 v91, v87
    s_mov_b32 s27, 33792
    s_mov_b32 s28, 67584
    s_mov_b32 s29, 0
    s_mov_b32 s30, 0x40000000
    s_mov_b32 s33, 9
    v_accvgpr_read_b32 v108, a0
    v_mfma_f32_16x16x32_bf16 a[88:91], a[180:183], v[204:207], a[88:91]
    v_accvgpr_read_b32 v109, a1
    v_accvgpr_read_b32 v110, a2
    v_mfma_f32_16x16x32_bf16 a[120:123], a[176:179], v[208:211], a[120:123]
    v_accvgpr_read_b32 v111, a3
    v_accvgpr_read_b32 v112, a4
    v_mfma_f32_16x16x32_bf16 a[120:123], a[180:183], v[212:215], a[120:123]
    v_accvgpr_read_b32 v113, a5
    v_accvgpr_read_b32 v114, a6
    v_mfma_f32_16x16x32_bf16 a[152:155], a[176:179], v[216:219], a[152:155]
    v_accvgpr_read_b32 v115, a7
    v_mul_f32 v108, v108, v100
    v_mfma_f32_16x16x32_bf16 a[28:31], a[184:187], v[184:187], a[28:31]
    v_mul_f32 v109, v109, v100
    v_mul_f32 v110, v110, v100
    v_mfma_f32_16x16x32_bf16 a[28:31], a[188:191], v[188:191], a[28:31]
    v_mul_f32 v111, v111, v100
    v_mul_f32 v112, v112, v100
    v_mfma_f32_16x16x32_bf16 a[60:63], a[184:187], v[192:195], a[60:63]
    v_mul_f32 v113, v113, v100
    v_mul_f32 v114, v114, v100
    v_mfma_f32_16x16x32_bf16 a[60:63], a[188:191], v[196:199], a[60:63]
    v_mul_f32 v115, v115, v100
    v_cvt_pk_bf16_f32 v148, v108, v109
    v_mfma_f32_16x16x32_bf16 a[92:95], a[184:187], v[200:203], a[92:95]
    v_cvt_pk_bf16_f32 v149, v110, v111
    v_cvt_pk_bf16_f32 v150, v112, v113
    v_mfma_f32_16x16x32_bf16 a[92:95], a[188:191], v[204:207], a[92:95]
    v_cvt_pk_bf16_f32 v151, v114, v115
    ds_write_b128 v92, v[148:151] offset:0
    v_mfma_f32_16x16x32_bf16 a[124:127], a[184:187], v[208:211], a[124:127]
    v_accvgpr_read_b32 v116, a32
    v_accvgpr_read_b32 v117, a33
    v_mfma_f32_16x16x32_bf16 a[124:127], a[188:191], v[212:215], a[124:127]
    v_accvgpr_read_b32 v118, a34
    v_accvgpr_read_b32 v119, a35
    v_mfma_f32_16x16x32_bf16 a[156:159], a[184:187], v[216:219], a[156:159]
    v_accvgpr_read_b32 v120, a36
    v_accvgpr_read_b32 v121, a37
    v_accvgpr_read_b32 v122, a38
    v_accvgpr_read_b32 v123, a39
    v_mul_f32 v116, v116, v101
    v_mul_f32 v117, v117, v101
    v_mul_f32 v118, v118, v101
    v_mul_f32 v119, v119, v101
    v_mul_f32 v120, v120, v101
    v_mul_f32 v121, v121, v101
    v_mul_f32 v122, v122, v101
    v_mul_f32 v123, v123, v101
    v_cvt_pk_bf16_f32 v152, v116, v117
    v_cvt_pk_bf16_f32 v153, v118, v119
    s_cmp_eq_u32 s25, 0
    s_cbranch_scc1 K1_M0
    ds_write_b128 v94, a[128:131] offset:0
    ds_write_b128 v94, a[132:135] offset:1024
    ds_write_b128 v94, a[136:139] offset:2048
    ds_write_b128 v94, a[140:143] offset:3072
    v_accvgpr_read_b32 v184, a144
    v_accvgpr_read_b32 v185, a145
    v_accvgpr_read_b32 v186, a146
    v_accvgpr_read_b32 v187, a147
    v_accvgpr_read_b32 v188, a148
    v_accvgpr_read_b32 v189, a149
    v_accvgpr_read_b32 v190, a150
    v_accvgpr_read_b32 v191, a151
    v_accvgpr_read_b32 v192, a152
    v_accvgpr_read_b32 v193, a153
    v_accvgpr_read_b32 v194, a154
    v_accvgpr_read_b32 v195, a155
    v_accvgpr_read_b32 v196, a156
    v_accvgpr_read_b32 v197, a157
    v_accvgpr_read_b32 v198, a158
    v_accvgpr_read_b32 v199, a159
    s_branch K1_M1
K1_M0:
    ds_write_b128 v94, a[144:147] offset:0
    ds_write_b128 v94, a[148:151] offset:1024
    ds_write_b128 v94, a[152:155] offset:2048
    ds_write_b128 v94, a[156:159] offset:3072
    v_accvgpr_read_b32 v184, a128
    v_accvgpr_read_b32 v185, a129
    v_accvgpr_read_b32 v186, a130
    v_accvgpr_read_b32 v187, a131
    v_accvgpr_read_b32 v188, a132
    v_accvgpr_read_b32 v189, a133
    v_accvgpr_read_b32 v190, a134
    v_accvgpr_read_b32 v191, a135
    v_accvgpr_read_b32 v192, a136
    v_accvgpr_read_b32 v193, a137
    v_accvgpr_read_b32 v194, a138
    v_accvgpr_read_b32 v195, a139
    v_accvgpr_read_b32 v196, a140
    v_accvgpr_read_b32 v197, a141
    v_accvgpr_read_b32 v198, a142
    v_accvgpr_read_b32 v199, a143
K1_M1:
    v_cvt_pk_bf16_f32 v154, v120, v121
    v_cvt_pk_bf16_f32 v155, v122, v123
    ds_write_b128 v92, v[152:155] offset:16896
    v_accvgpr_read_b32 v108, a64
    v_accvgpr_read_b32 v109, a65
    v_accvgpr_read_b32 v110, a66
    v_accvgpr_read_b32 v111, a67
    v_accvgpr_read_b32 v112, a68
    v_accvgpr_read_b32 v113, a69
    v_accvgpr_read_b32 v114, a70
    v_accvgpr_read_b32 v115, a71
    v_mul_f32 v108, v108, v102
    v_mul_f32 v109, v109, v102
    v_mul_f32 v110, v110, v102
    v_mul_f32 v111, v111, v102
    v_mul_f32 v112, v112, v102
    v_mul_f32 v113, v113, v102
    v_mul_f32 v114, v114, v102
    v_mul_f32 v115, v115, v102
    v_cvt_pk_bf16_f32 v156, v108, v109
    v_cvt_pk_bf16_f32 v157, v110, v111
    v_cvt_pk_bf16_f32 v158, v112, v113
    v_cvt_pk_bf16_f32 v159, v114, v115
    ds_write_b128 v92, v[156:159] offset:33792
    v_accvgpr_read_b32 v116, a96
    v_accvgpr_read_b32 v117, a97
    v_accvgpr_read_b32 v118, a98
    v_accvgpr_read_b32 v119, a99
    v_accvgpr_read_b32 v120, a100
    v_accvgpr_read_b32 v121, a101
    v_accvgpr_read_b32 v122, a102
    v_accvgpr_read_b32 v123, a103
    v_mul_f32 v116, v116, v103
    v_mul_f32 v117, v117, v103
    v_mul_f32 v118, v118, v103
    v_mul_f32 v119, v119, v103
    v_mul_f32 v120, v120, v103
    v_mul_f32 v121, v121, v103
    v_mul_f32 v122, v122, v103
    v_mul_f32 v123, v123, v103
    v_cvt_pk_bf16_f32 v160, v116, v117
    v_cvt_pk_bf16_f32 v161, v118, v119
    v_cvt_pk_bf16_f32 v162, v120, v121
    v_cvt_pk_bf16_f32 v163, v122, v123
    ds_write_b128 v92, v[160:163] offset:50688
    v_accvgpr_read_b32 v108, a8
    v_accvgpr_read_b32 v109, a9
    v_accvgpr_read_b32 v110, a10
    v_accvgpr_read_b32 v111, a11
    v_accvgpr_read_b32 v112, a12
    v_accvgpr_read_b32 v113, a13
    v_accvgpr_read_b32 v114, a14
    v_accvgpr_read_b32 v115, a15
    v_mul_f32 v108, v108, v100
    v_mul_f32 v109, v109, v100
    v_mul_f32 v110, v110, v100
    v_mul_f32 v111, v111, v100
    v_mul_f32 v112, v112, v100
    v_mul_f32 v113, v113, v100
    v_mul_f32 v114, v114, v100
    v_mul_f32 v115, v115, v100
    v_cvt_pk_bf16_f32 v164, v108, v109
    v_cvt_pk_bf16_f32 v165, v110, v111
    v_cvt_pk_bf16_f32 v166, v112, v113
    v_cvt_pk_bf16_f32 v167, v114, v115
    ds_write_b128 v92, v[164:167] offset:1024
    v_accvgpr_read_b32 v116, a40
    v_accvgpr_read_b32 v117, a41
    v_accvgpr_read_b32 v118, a42
    v_accvgpr_read_b32 v119, a43
    v_accvgpr_read_b32 v120, a44
    v_accvgpr_read_b32 v121, a45
    v_accvgpr_read_b32 v122, a46
    v_accvgpr_read_b32 v123, a47
    v_mul_f32 v116, v116, v101
    v_mul_f32 v117, v117, v101
    v_mul_f32 v118, v118, v101
    v_mul_f32 v119, v119, v101
    v_mul_f32 v120, v120, v101
    v_mul_f32 v121, v121, v101
    v_mul_f32 v122, v122, v101
    v_mul_f32 v123, v123, v101
    v_cvt_pk_bf16_f32 v168, v116, v117
    v_cvt_pk_bf16_f32 v169, v118, v119
    v_cvt_pk_bf16_f32 v170, v120, v121
    v_cvt_pk_bf16_f32 v171, v122, v123
    ds_write_b128 v92, v[168:171] offset:17920
    v_accvgpr_read_b32 v108, a72
    v_accvgpr_read_b32 v109, a73
    v_accvgpr_read_b32 v110, a74
    v_accvgpr_read_b32 v111, a75
    v_accvgpr_read_b32 v112, a76
    v_accvgpr_read_b32 v113, a77
    v_accvgpr_read_b32 v114, a78
    v_accvgpr_read_b32 v115, a79
    v_mul_f32 v108, v108, v102
    v_mul_f32 v109, v109, v102
    v_mul_f32 v110, v110, v102
    v_mul_f32 v111, v111, v102
    v_mul_f32 v112, v112, v102
    v_mul_f32 v113, v113, v102
    v_mul_f32 v114, v114, v102
    v_mul_f32 v115, v115, v102
    v_cvt_pk_bf16_f32 v172, v108, v109
    v_cvt_pk_bf16_f32 v173, v110, v111
    v_cvt_pk_bf16_f32 v174, v112, v113
    v_cvt_pk_bf16_f32 v175, v114, v115
    ds_write_b128 v92, v[172:175] offset:34816
    v_accvgpr_read_b32 v116, a104
    v_accvgpr_read_b32 v117, a105
    v_accvgpr_read_b32 v118, a106
    v_accvgpr_read_b32 v119, a107
    v_accvgpr_read_b32 v120, a108
    v_accvgpr_read_b32 v121, a109
    v_accvgpr_read_b32 v122, a110
    v_accvgpr_read_b32 v123, a111
    v_mul_f32 v116, v116, v103
    v_mul_f32 v117, v117, v103
    v_mul_f32 v118, v118, v103
    v_mul_f32 v119, v119, v103
    v_mul_f32 v120, v120, v103
    v_mul_f32 v121, v121, v103
    v_mul_f32 v122, v122, v103
    v_mul_f32 v123, v123, v103
    v_cvt_pk_bf16_f32 v176, v116, v117
    v_cvt_pk_bf16_f32 v177, v118, v119
    v_cvt_pk_bf16_f32 v178, v120, v121
    v_cvt_pk_bf16_f32 v179, v122, v123
    ds_write_b128 v92, v[176:179] offset:51712
    v_accvgpr_read_b32 v108, a16
    v_accvgpr_read_b32 v109, a17
    v_accvgpr_read_b32 v110, a18
    v_accvgpr_read_b32 v111, a19
    v_accvgpr_read_b32 v112, a20
    v_accvgpr_read_b32 v113, a21
    v_accvgpr_read_b32 v114, a22
    v_accvgpr_read_b32 v115, a23
    v_mul_f32 v108, v108, v100
    v_mul_f32 v109, v109, v100
    v_mul_f32 v110, v110, v100
    v_mul_f32 v111, v111, v100
    v_mul_f32 v112, v112, v100
    v_mul_f32 v113, v113, v100
    v_mul_f32 v114, v114, v100
    v_mul_f32 v115, v115, v100
    v_cvt_pk_bf16_f32 v220, v108, v109
    v_cvt_pk_bf16_f32 v221, v110, v111
    v_cvt_pk_bf16_f32 v222, v112, v113
    v_cvt_pk_bf16_f32 v223, v114, v115
    ds_write_b128 v92, v[220:223] offset:2048
    v_accvgpr_read_b32 v116, a48
    v_accvgpr_read_b32 v117, a49
    v_accvgpr_read_b32 v118, a50
    v_accvgpr_read_b32 v119, a51
    v_accvgpr_read_b32 v120, a52
    v_accvgpr_read_b32 v121, a53
    v_accvgpr_read_b32 v122, a54
    v_accvgpr_read_b32 v123, a55
    v_mul_f32 v116, v116, v101
    v_mul_f32 v117, v117, v101
    v_mul_f32 v118, v118, v101
    v_mul_f32 v119, v119, v101
    v_mul_f32 v120, v120, v101
    v_mul_f32 v121, v121, v101
    v_mul_f32 v122, v122, v101
    v_mul_f32 v123, v123, v101
    v_cvt_pk_bf16_f32 v224, v116, v117
    v_cvt_pk_bf16_f32 v225, v118, v119
    v_cvt_pk_bf16_f32 v226, v120, v121
    v_cvt_pk_bf16_f32 v227, v122, v123
    ds_write_b128 v92, v[224:227] offset:18944
    v_accvgpr_read_b32 v108, a80
    v_accvgpr_read_b32 v109, a81
    v_accvgpr_read_b32 v110, a82
    v_accvgpr_read_b32 v111, a83
    v_accvgpr_read_b32 v112, a84
    v_accvgpr_read_b32 v113, a85
    v_accvgpr_read_b32 v114, a86
    v_accvgpr_read_b32 v115, a87
    v_mul_f32 v108, v108, v102
    v_mul_f32 v109, v109, v102
    v_mul_f32 v110, v110, v102
    v_mul_f32 v111, v111, v102
    v_mul_f32 v112, v112, v102
    v_mul_f32 v113, v113, v102
    v_mul_f32 v114, v114, v102
    v_mul_f32 v115, v115, v102
    v_cvt_pk_bf16_f32 v228, v108, v109
    v_cvt_pk_bf16_f32 v229, v110, v111
    v_cvt_pk_bf16_f32 v230, v112, v113
    v_cvt_pk_bf16_f32 v231, v114, v115
    ds_write_b128 v92, v[228:231] offset:35840
    v_accvgpr_read_b32 v116, a112
    v_accvgpr_read_b32 v117, a113
    v_accvgpr_read_b32 v118, a114
    v_accvgpr_read_b32 v119, a115
    v_accvgpr_read_b32 v120, a116
    v_accvgpr_read_b32 v121, a117
    v_accvgpr_read_b32 v122, a118
    v_accvgpr_read_b32 v123, a119
    v_mul_f32 v116, v116, v103
    v_mul_f32 v117, v117, v103
    v_mul_f32 v118, v118, v103
    v_mul_f32 v119, v119, v103
    v_mul_f32 v120, v120, v103
    v_mul_f32 v121, v121, v103
    v_mul_f32 v122, v122, v103
    v_mul_f32 v123, v123, v103
    v_cvt_pk_bf16_f32 v232, v116, v117
    v_cvt_pk_bf16_f32 v233, v118, v119
    v_cvt_pk_bf16_f32 v234, v120, v121
    v_cvt_pk_bf16_f32 v235, v122, v123
    ds_write_b128 v92, v[232:235] offset:52736
    v_accvgpr_read_b32 v108, a24
    v_accvgpr_read_b32 v109, a25
    v_accvgpr_read_b32 v110, a26
    v_accvgpr_read_b32 v111, a27
    v_accvgpr_read_b32 v112, a28
    v_accvgpr_read_b32 v113, a29
    v_accvgpr_read_b32 v114, a30
    v_accvgpr_read_b32 v115, a31
    v_mul_f32 v108, v108, v100
    v_mul_f32 v109, v109, v100
    v_mul_f32 v110, v110, v100
    v_mul_f32 v111, v111, v100
    v_mul_f32 v112, v112, v100
    v_mul_f32 v113, v113, v100
    v_mul_f32 v114, v114, v100
    v_mul_f32 v115, v115, v100
    v_cvt_pk_bf16_f32 v236, v108, v109
    v_cvt_pk_bf16_f32 v237, v110, v111
    v_cvt_pk_bf16_f32 v238, v112, v113
    v_cvt_pk_bf16_f32 v239, v114, v115
    ds_write_b128 v92, v[236:239] offset:3072
    v_accvgpr_read_b32 v116, a56
    v_accvgpr_read_b32 v117, a57
    v_accvgpr_read_b32 v118, a58
    v_accvgpr_read_b32 v119, a59
    v_accvgpr_read_b32 v120, a60
    v_accvgpr_read_b32 v121, a61
    v_accvgpr_read_b32 v122, a62
    v_accvgpr_read_b32 v123, a63
    v_mul_f32 v116, v116, v101
    v_mul_f32 v117, v117, v101
    v_mul_f32 v118, v118, v101
    v_mul_f32 v119, v119, v101
    v_mul_f32 v120, v120, v101
    v_mul_f32 v121, v121, v101
    v_mul_f32 v122, v122, v101
    v_mul_f32 v123, v123, v101
    v_cvt_pk_bf16_f32 v240, v116, v117
    v_cvt_pk_bf16_f32 v241, v118, v119
    v_cvt_pk_bf16_f32 v242, v120, v121
    v_cvt_pk_bf16_f32 v243, v122, v123
    ds_write_b128 v92, v[240:243] offset:19968
    v_accvgpr_read_b32 v108, a88
    v_accvgpr_read_b32 v109, a89
    v_accvgpr_read_b32 v110, a90
    v_accvgpr_read_b32 v111, a91
    v_accvgpr_read_b32 v112, a92
    v_accvgpr_read_b32 v113, a93
    v_accvgpr_read_b32 v114, a94
    v_accvgpr_read_b32 v115, a95
    v_mul_f32 v108, v108, v102
    v_mul_f32 v109, v109, v102
    v_mul_f32 v110, v110, v102
    v_mul_f32 v111, v111, v102
    v_mul_f32 v112, v112, v102
    v_mul_f32 v113, v113, v102
    v_mul_f32 v114, v114, v102
    v_mul_f32 v115, v115, v102
    v_cvt_pk_bf16_f32 v244, v108, v109
    v_cvt_pk_bf16_f32 v245, v110, v111
    v_cvt_pk_bf16_f32 v246, v112, v113
    v_cvt_pk_bf16_f32 v247, v114, v115
    ds_write_b128 v92, v[244:247] offset:36864
    v_accvgpr_read_b32 v116, a120
    v_accvgpr_read_b32 v117, a121
    v_accvgpr_read_b32 v118, a122
    v_accvgpr_read_b32 v119, a123
    v_accvgpr_read_b32 v120, a124
    v_accvgpr_read_b32 v121, a125
    v_accvgpr_read_b32 v122, a126
    v_accvgpr_read_b32 v123, a127
    v_mul_f32 v116, v116, v103
    v_mul_f32 v117, v117, v103
    v_mul_f32 v118, v118, v103
    v_mul_f32 v119, v119, v103
    v_mul_f32 v120, v120, v103
    v_mul_f32 v121, v121, v103
    v_mul_f32 v122, v122, v103
    v_mul_f32 v123, v123, v103
    v_cvt_pk_bf16_f32 v248, v116, v117
    v_cvt_pk_bf16_f32 v249, v118, v119
    v_cvt_pk_bf16_f32 v250, v120, v121
    v_cvt_pk_bf16_f32 v251, v122, v123
    ds_write_b128 v92, v[248:251] offset:53760
    v_mov_b32 v15, 160256
    s_waitcnt vmcnt(0) lgkmcnt(0)
    s_barrier
    ds_read_b32 v9, v14
    ds_read_b128 v[200:203], v95 offset:0
    ds_read_b128 v[204:207], v95 offset:1024
    ds_read_b128 v[208:211], v95 offset:2048
    ds_read_b128 v[212:215], v95 offset:3072
    ds_read_b64_tr_b16 a[4:5], v88 offset:0
    ds_read_b64_tr_b16 a[6:7], v88 offset:512
    ds_read_b64_tr_b16 a[36:37], v88 offset:4224
    ds_read_b64_tr_b16 a[38:39], v88 offset:4736
    ds_read_b64_tr_b16 a[68:69], v88 offset:8448
    ds_read_b64_tr_b16 a[70:71], v88 offset:8960
    ds_read_b64_tr_b16 a[100:101], v88 offset:12672
    ds_read_b64_tr_b16 a[102:103], v88 offset:13184
    ds_read_b64_tr_b16 a[12:13], v89 offset:0
    ds_read_b64_tr_b16 a[14:15], v89 offset:512
    ds_read_b64_tr_b16 a[44:45], v89 offset:4224
    ds_read_b64_tr_b16 a[46:47], v89 offset:4736
    ds_read_b64_tr_b16 a[76:77], v89 offset:8448
    ds_read_b64_tr_b16 a[78:79], v89 offset:8960
    ds_read_b64_tr_b16 a[108:109], v89 offset:12672
    ds_read_b64_tr_b16 a[110:111], v89 offset:13184
    ds_read_b128 a[0:3], v93 offset:0
    ds_read_b128 a[8:11], v93 offset:1024
    ds_read_b128 a[16:19], v93 offset:2048
    ds_read_b128 a[24:27], v93 offset:3072
    ds_read_b128 a[32:35], v93 offset:16896
    ds_read_b128 a[40:43], v93 offset:17920
    ds_read_b128 a[48:51], v93 offset:18944
    ds_read_b128 a[56:59], v93 offset:19968
    ds_read_b128 a[64:67], v93 offset:33792
    ds_read_b128 a[72:75], v93 offset:34816
    ds_read_b128 a[80:83], v93 offset:35840
    ds_read_b128 a[88:91], v93 offset:36864
    ds_read_b128 a[96:99], v93 offset:50688
    ds_read_b128 a[104:107], v93 offset:51712
    ds_read_b128 a[112:115], v93 offset:52736
    ds_read_b128 a[120:123], v93 offset:53760
    ds_read_b128 v[216:219], v15
    s_waitcnt lgkmcnt(15)
    v_add_f32 v104, v104, v9
    v_rcp_f32 v104, v104
    v_add_f32 v184, v184, v200
    v_add_f32 v185, v185, v201
    v_add_f32 v186, v186, v202
    v_add_f32 v187, v187, v203
    v_add_f32 v188, v188, v204
    v_add_f32 v189, v189, v205
    v_add_f32 v190, v190, v206
    v_add_f32 v191, v191, v207
    v_add_f32 v192, v192, v208
    v_add_f32 v193, v193, v209
    v_add_f32 v194, v194, v210
    v_add_f32 v195, v195, v211
    v_add_f32 v196, v196, v212
    v_add_f32 v197, v197, v213
    v_add_f32 v198, v198, v214
    v_add_f32 v199, v199, v215
    v_mul_f32 v184, v184, v104
    v_mul_f32 v185, v185, v104
    v_mul_f32 v186, v186, v104
    v_mul_f32 v187, v187, v104
    v_mul_f32 v188, v188, v104
    v_mul_f32 v189, v189, v104
    v_mul_f32 v190, v190, v104
    v_mul_f32 v191, v191, v104
    v_mul_f32 v192, v192, v104
    v_mul_f32 v193, v193, v104
    v_mul_f32 v194, v194, v104
    v_mul_f32 v195, v195, v104
    v_mul_f32 v196, v196, v104
    v_mul_f32 v197, v197, v104
    v_mul_f32 v198, v198, v104
    v_mul_f32 v199, v199, v104
    v_cvt_pk_bf16_f32 v200, v184, v185
    v_cvt_pk_bf16_f32 v201, v186, v187
    v_cvt_pk_bf16_f32 v202, v188, v189
    v_cvt_pk_bf16_f32 v203, v190, v191
    v_cvt_pk_bf16_f32 v204, v192, v193
    v_cvt_pk_bf16_f32 v205, v194, v195
    v_cvt_pk_bf16_f32 v206, v196, v197
    v_cvt_pk_bf16_f32 v207, v198, v199
    ds_write_b128 v96, v[200:203] offset:0
    ds_write_b128 v96, v[204:207] offset:1024
    s_add_u32 m0, s67, s28
    s_waitcnt lgkmcnt(2)
K1_FL:
    v_mfma_f32_16x16x32_bf16 v[108:111], a[4:7], v[148:151], 0
    ds_read_b64_tr_b16 a[20:21], v90 offset:0
    v_mfma_f32_16x16x32_bf16 v[108:111], a[36:39], v[164:167], v[108:111]
    buffer_load_dwordx4 v80, s[56:59], s31 offen offset:0 lds
    v_mfma_f32_16x16x32_bf16 v[108:111], a[68:71], v[220:223], v[108:111]
    ds_read_b64_tr_b16 a[22:23], v90 offset:512
    v_mfma_f32_16x16x32_bf16 v[108:111], a[100:103], v[236:239], v[108:111]
    ds_read_b64_tr_b16 a[52:53], v90 offset:4224
    v_cvt_pk_bf16_f32 v136, v116, v117
    v_mfma_f32_16x16x32_bf16 v[108:111], a[12:15], a[0:3], v[108:111]
    ds_read_b64_tr_b16 a[54:55], v90 offset:4736
    v_cvt_pk_bf16_f32 v137, v118, v119
    v_mfma_f32_16x16x32_bf16 v[108:111], a[44:47], a[8:11], v[108:111]
    buffer_store_dwordx2 v[136:137], v99, s[20:23], s30 offen sc1
    v_mfma_f32_16x16x32_bf16 v[108:111], a[76:79], a[16:19], v[108:111]
    ds_read_b64_tr_b16 a[84:85], v90 offset:8448
    v_mfma_f32_16x16x32_bf16 v[108:111], a[108:111], a[24:27], v[108:111]
    s_lshr_b32 s30, s29, 3
    ds_read_b64_tr_b16 a[86:87], v90 offset:8960
    v_mfma_f32_16x16x32_bf16 v[112:115], a[4:7], v[152:155], 0
    ds_read_b64_tr_b16 a[116:117], v90 offset:12672
    v_mfma_f32_16x16x32_bf16 v[112:115], a[36:39], v[168:171], v[112:115]
    ds_read_b64_tr_b16 a[118:119], v90 offset:13184
    v_mfma_f32_16x16x32_bf16 v[112:115], a[68:71], v[224:227], v[112:115]
    buffer_load_dwordx4 v81, s[56:59], s31 offen offset:1056 lds
    v_mfma_f32_16x16x32_bf16 v[112:115], a[100:103], v[240:243], v[112:115]
    ds_read_b64_tr_b16 a[28:29], v91 offset:0
    v_cvt_pk_bf16_f32 v120, v108, v109
    v_mfma_f32_16x16x32_bf16 v[112:115], a[12:15], a[32:35], v[112:115]
    ds_read_b64_tr_b16 a[30:31], v91 offset:512
    v_cvt_pk_bf16_f32 v121, v110, v111
    v_mfma_f32_16x16x32_bf16 v[112:115], a[44:47], a[40:43], v[112:115]
    ds_read_b64_tr_b16 a[60:61], v91 offset:4224
    v_mfma_f32_16x16x32_bf16 v[112:115], a[76:79], a[48:51], v[112:115]
    ds_read_b64_tr_b16 a[62:63], v91 offset:4736
    v_mfma_f32_16x16x32_bf16 v[112:115], a[108:111], a[56:59], v[112:115]
    ds_read_b64_tr_b16 a[92:93], v91 offset:8448
    v_mfma_f32_16x16x32_bf16 v[116:119], a[4:7], v[156:159], 0
    buffer_load_dwordx4 v82, s[56:59], s31 offen offset:2112 lds
    v_mfma_f32_16x16x32_bf16 v[116:119], a[36:39], v[172:175], v[116:119]
    ds_read_b64_tr_b16 a[94:95], v91 offset:8960
    v_mfma_f32_16x16x32_bf16 v[116:119], a[68:71], v[228:231], v[116:119]
    ds_read_b64_tr_b16 a[124:125], v91 offset:12672
    v_mfma_f32_16x16x32_bf16 v[116:119], a[100:103], v[244:247], v[116:119]
    ds_read_b64_tr_b16 a[126:127], v91 offset:13184
    v_cvt_pk_bf16_f32 v124, v112, v113
    v_mfma_f32_16x16x32_bf16 v[116:119], a[12:15], a[64:67], v[116:119]
    v_cvt_pk_bf16_f32 v125, v114, v115
    v_add_u32 v88, s27, v84
    v_mfma_f32_16x16x32_bf16 v[116:119], a[44:47], a[72:75], v[116:119]
    v_add_u32 v89, s27, v85
    v_add_u32 v90, s27, v86
    v_mfma_f32_16x16x32_bf16 v[116:119], a[76:79], a[80:83], v[116:119]
    buffer_load_dwordx4 v83, s[56:59], s31 offen offset:3168 lds
    v_mfma_f32_16x16x32_bf16 v[116:119], a[108:111], a[88:91], v[116:119]
    s_add_u32 m0, m0, 16896
    v_add_u32 v91, s27, v87
    v_mfma_f32_16x16x32_bf16 v[108:111], a[4:7], v[160:163], 0
    v_mfma_f32_16x16x32_bf16 v[108:111], a[36:39], v[176:179], v[108:111]
    v_mfma_f32_16x16x32_bf16 v[108:111], a[68:71], v[232:235], v[108:111]
    v_mfma_f32_16x16x32_bf16 v[108:111], a[100:103], v[248:251], v[108:111]
    s_nop 1
    v_cvt_pk_bf16_f32 v128, v116, v117
    v_mfma_f32_16x16x32_bf16 v[108:111], a[12:15], a[96:99], v[108:111]
    v_cvt_pk_bf16_f32 v129, v118, v119
    v_mfma_f32_16x16x32_bf16 v[108:111], a[44:47], a[104:107], v[108:111]
    buffer_load_dwordx4 v80, s[56:59], s32 offen offset:0 lds
    v_mfma_f32_16x16x32_bf16 v[108:111], a[76:79], a[112:115], v[108:111]
    s_waitcnt vmcnt(9) lgkmcnt(0)
    v_mfma_f32_16x16x32_bf16 v[108:111], a[108:111], a[120:123], v[108:111]
    s_barrier
    ds_read_b128 a[128:131], v97 offset:0
    v_mfma_f32_16x16x32_bf16 v[112:115], a[20:23], v[148:151], 0
    ds_read_b128 a[132:135], v97 offset:1024
    v_mfma_f32_16x16x32_bf16 v[112:115], a[52:55], v[164:167], v[112:115]
    ds_read_b128 a[136:139], v97 offset:2048
    v_mfma_f32_16x16x32_bf16 v[112:115], a[84:87], v[220:223], v[112:115]
    buffer_load_dwordx4 v81, s[56:59], s32 offen offset:1056 lds
    v_mfma_f32_16x16x32_bf16 v[112:115], a[116:119], v[236:239], v[112:115]
    ds_read_b128 a[140:143], v97 offset:3072
    v_cvt_pk_bf16_f32 v132, v108, v109
    v_mfma_f32_16x16x32_bf16 v[112:115], a[28:31], a[0:3], v[112:115]
    ds_read_b128 a[144:147], v98 offset:0
    v_cvt_pk_bf16_f32 v133, v110, v111
    v_mfma_f32_16x16x32_bf16 v[112:115], a[60:63], a[8:11], v[112:115]
    ds_read_b128 a[148:151], v98 offset:1024
    v_mfma_f32_16x16x32_bf16 v[112:115], a[92:95], a[16:19], v[112:115]
    ds_read_b128 a[152:155], v98 offset:2048
    v_mfma_f32_16x16x32_bf16 v[112:115], a[124:127], a[24:27], v[112:115]
    ds_read_b128 a[156:159], v98 offset:3072
    v_mfma_f32_16x16x32_bf16 v[116:119], a[20:23], v[152:155], 0
    buffer_load_dwordx4 v82, s[56:59], s32 offen offset:2112 lds
    v_mfma_f32_16x16x32_bf16 v[116:119], a[52:55], v[168:171], v[116:119]
    ds_read_b64_tr_b16 a[4:5], v88 offset:0
    v_mfma_f32_16x16x32_bf16 v[116:119], a[84:87], v[224:227], v[116:119]
    ds_read_b64_tr_b16 a[6:7], v88 offset:512
    v_mfma_f32_16x16x32_bf16 v[116:119], a[116:119], v[240:243], v[116:119]
    ds_read_b64_tr_b16 a[36:37], v88 offset:4224
    v_cvt_pk_bf16_f32 v122, v112, v113
    v_mfma_f32_16x16x32_bf16 v[116:119], a[28:31], a[32:35], v[116:119]
    ds_read_b64_tr_b16 a[38:39], v88 offset:4736
    v_cvt_pk_bf16_f32 v123, v114, v115
    v_mfma_f32_16x16x32_bf16 v[116:119], a[60:63], a[40:43], v[116:119]
    buffer_store_dwordx4 v[120:123], v8, s[20:23], s29 offen offset:0 sc1
    v_mfma_f32_16x16x32_bf16 v[116:119], a[92:95], a[48:51], v[116:119]
    ds_read_b64_tr_b16 a[68:69], v88 offset:8448
    v_mfma_f32_16x16x32_bf16 v[116:119], a[124:127], a[56:59], v[116:119]
    ds_read_b64_tr_b16 a[70:71], v88 offset:8960
    v_mfma_f32_16x16x32_bf16 v[108:111], a[20:23], v[156:159], 0
    ds_read_b64_tr_b16 a[100:101], v88 offset:12672
    v_mfma_f32_16x16x32_bf16 v[108:111], a[52:55], v[172:175], v[108:111]
    buffer_load_dwordx4 v83, s[56:59], s32 offen offset:3168 lds
    v_mfma_f32_16x16x32_bf16 v[108:111], a[84:87], v[228:231], v[108:111]
    s_add_u32 s31, s31, 128
    ds_read_b64_tr_b16 a[102:103], v88 offset:13184
    v_mfma_f32_16x16x32_bf16 v[108:111], a[116:119], v[244:247], v[108:111]
    s_add_u32 s32, s32, 128
    ds_read_b64_tr_b16 a[12:13], v89 offset:0
    v_cvt_pk_bf16_f32 v126, v116, v117
    v_mfma_f32_16x16x32_bf16 v[108:111], a[28:31], a[64:67], v[108:111]
    s_mov_b32 s27, s28
    ds_read_b64_tr_b16 a[14:15], v89 offset:512
    v_cvt_pk_bf16_f32 v127, v118, v119
    v_mfma_f32_16x16x32_bf16 v[108:111], a[60:63], a[72:75], v[108:111]
    s_add_u32 s28, s28, 33792
    buffer_store_dwordx4 v[124:127], v8, s[20:23], s29 offen offset:1024 sc1
    v_mfma_f32_16x16x32_bf16 v[108:111], a[92:95], a[80:83], v[108:111]
    s_cmp_eq_u32 s28, 135168
    ds_read_b64_tr_b16 a[44:45], v89 offset:4224
    v_mfma_f32_16x16x32_bf16 v[108:111], a[124:127], a[88:91], v[108:111]
    s_cselect_b32 s28, 0, s28
    ds_read_b64_tr_b16 a[46:47], v89 offset:4736
    v_mfma_f32_16x16x32_bf16 v[112:115], a[20:23], v[160:163], 0
    s_add_u32 m0, s67, s28
    ds_read_b64_tr_b16 a[76:77], v89 offset:8448
    v_mfma_f32_16x16x32_bf16 v[112:115], a[52:55], v[176:179], v[112:115]
    s_sub_u32 s33, s33, 1
    ds_read_b64_tr_b16 a[78:79], v89 offset:8960
    v_mfma_f32_16x16x32_bf16 v[112:115], a[84:87], v[232:235], v[112:115]
    s_cmp_le_u32 s33, 2
    ds_read_b64_tr_b16 a[108:109], v89 offset:12672
    v_mfma_f32_16x16x32_bf16 v[112:115], a[116:119], v[248:251], v[112:115]
    s_cselect_b32 s31, 0x40000000, s31
    ds_read_b64_tr_b16 a[110:111], v89 offset:13184
    v_cvt_pk_bf16_f32 v130, v108, v109
    v_mfma_f32_16x16x32_bf16 v[112:115], a[28:31], a[96:99], v[112:115]
    s_cselect_b32 s32, 0x40000000, s32
    v_cvt_pk_bf16_f32 v131, v110, v111
    v_mfma_f32_16x16x32_bf16 v[112:115], a[60:63], a[104:107], v[112:115]
    buffer_store_dwordx4 v[128:131], v8, s[20:23], s29 offen offset:2048 sc1
    v_mfma_f32_16x16x32_bf16 v[112:115], a[92:95], a[112:115], v[112:115]
    v_mfma_f32_16x16x32_bf16 v[112:115], a[124:127], a[120:123], v[112:115]
    s_waitcnt lgkmcnt(15)
    v_mfma_f32_16x16x32_bf16 v[116:119], a[20:23], a[128:131], 0
    v_mfma_f32_16x16x32_bf16 v[116:119], a[52:55], a[132:135], v[116:119]
    v_mfma_f32_16x16x32_bf16 v[116:119], a[84:87], a[136:139], v[116:119]
    v_mfma_f32_16x16x32_bf16 v[116:119], a[116:119], a[140:143], v[116:119]
    s_nop 2
    v_cvt_pk_bf16_f32 v134, v112, v113
    v_mfma_f32_16x16x32_bf16 v[116:119], a[28:31], a[144:147], v[116:119]
    v_cvt_pk_bf16_f32 v135, v114, v115
    v_mfma_f32_16x16x32_bf16 v[116:119], a[60:63], a[148:151], v[116:119]
    buffer_store_dwordx4 v[132:135], v8, s[20:23], s29 offen offset:3072 sc1
    v_mfma_f32_16x16x32_bf16 v[116:119], a[92:95], a[152:155], v[116:119]
    s_add_u32 s29, s29, 16384
    v_mfma_f32_16x16x32_bf16 v[116:119], a[124:127], a[156:159], v[116:119]
    s_cmp_lg_u32 s33, 0
    s_waitcnt lgkmcnt(0)
    s_cbranch_scc1 K1_FL
    v_or_b32 v216, v216, v217
    v_or3_b32 v216, v216, v218, v219
    s_nop 1
    v_readfirstlane_b32 s64, v216
    v_cvt_pk_bf16_f32 v136, v116, v117
    v_cvt_pk_bf16_f32 v137, v118, v119
    buffer_store_dwordx2 v[136:137], v99, s[20:23], s30 offen sc1
    s_cmp_lg_u32 s64, 0
    s_cbranch_scc1 K1_FALLBACK
K1_END:
    s_endpgm
K1_FALLBACK:
    s_waitcnt vmcnt(0) lgkmcnt(0)
    s_barrier
    s_mov_b32 s62, 0
    s_mov_b32 s100, 1073741824
    v_and_b32 v9, 15, v0
    v_lshrrev_b32 v10, 4, v0
    v_lshlrev_b32 v9, 8, v9
    v_lshl_add_u32 v9, v10, 4, v9
    s_lshl_b32 s63, s25, 7
    s_xor_b32 s64, s63, 128
    v_add_u32 v10, s64, v9
    v_add_u32 v9, s63, v9
    s_mov_b32 s65, 0
    v_mov_b32 v80, 0xff800000
    v_mov_b32 v81, 0xff800000
    v_mov_b32 v82, 0xff800000
    v_mov_b32 v83, 0xff800000
    v_mov_b32 v84, 0xff800000
    v_mov_b32 v85, 0xff800000
    v_mov_b32 v86, 0xff800000
    v_mov_b32 v87, 0xff800000
    v_mov_b32 v88, 0xff800000
    v_mov_b32 v89, 0xff800000
    v_mov_b32 v90, 0xff800000
    v_mov_b32 v91, 0xff800000
    v_mov_b32 v92, 0xff800000
    v_mov_b32 v93, 0xff800000
    v_mov_b32 v94, 0xff800000
    v_mov_b32 v95, 0xff800000
    v_mov_b32 v96, 0xff800000
    v_mov_b32 v97, 0xff800000
    v_mov_b32 v98, 0xff800000
    v_mov_b32 v99, 0xff800000
K1_FBLOOP:
    buffer_load_dwordx4 v[220:223], v9, s[12:15], s65 offen offset:0
    buffer_load_dwordx4 v[224:227], v9, s[12:15], s65 offen offset:64
    buffer_load_dwordx4 v[228:231], v10, s[12:15], s65 offen offset:0
    buffer_load_dwordx4 v[232:235], v10, s[12:15], s65 offen offset:64
    s_waitcnt vmcnt(0)
    v_mfma_f32_16x16x32_bf16 v[108:111], v[220:223], v[16:19], 0
    v_mfma_f32_16x16x32_bf16 v[108:111], v[224:227], v[20:23], v[108:111]
    v_mfma_f32_16x16x32_bf16 v[108:111], v[228:231], v[24:27], v[108:111]
    v_mfma_f32_16x16x32_bf16 v[108:111], v[232:235], v[28:31], v[108:111]
    v_mfma_f32_16x16x32_bf16 v[112:115], v[220:223], v[32:35], 0
    v_mfma_f32_16x16x32_bf16 v[112:115], v[224:227], v[36:39], v[112:115]
    v_mfma_f32_16x16x32_bf16 v[112:115], v[228:231], v[40:43], v[112:115]
    v_mfma_f32_16x16x32_bf16 v[112:115], v[232:235], v[44:47], v[112:115]
    v_mfma_f32_16x16x32_bf16 v[116:119], v[220:223], v[48:51], 0
    v_mfma_f32_16x16x32_bf16 v[116:119], v[224:227], v[52:55], v[116:119]
    v_mfma_f32_16x16x32_bf16 v[116:119], v[228:231], v[56:59], v[116:119]
    v_mfma_f32_16x16x32_bf16 v[116:119], v[232:235], v[60:63], v[116:119]
    v_mfma_f32_16x16x32_bf16 v[120:123], v[220:223], v[64:67], 0
    v_mfma_f32_16x16x32_bf16 v[120:123], v[224:227], v[68:71], v[120:123]
    v_mfma_f32_16x16x32_bf16 v[120:123], v[228:231], v[72:75], v[120:123]
    v_mfma_f32_16x16x32_bf16 v[120:123], v[232:235], v[76:79], v[120:123]
    v_mfma_f32_16x16x32_bf16 v[124:127], v[220:223], a[192:195], 0
    v_mfma_f32_16x16x32_bf16 v[124:127], v[224:227], a[196:199], v[124:127]
    v_mfma_f32_16x16x32_bf16 v[124:127], v[228:231], a[200:203], v[124:127]
    v_mfma_f32_16x16x32_bf16 v[124:127], v[232:235], a[204:207], v[124:127]
    s_nop 7
    v_max_f32 v80, v80, v108
    v_max_f32 v81, v81, v109
    v_max_f32 v82, v82, v110
    v_max_f32 v83, v83, v111
    v_max_f32 v84, v84, v112
    v_max_f32 v85, v85, v113
    v_max_f32 v86, v86, v114
    v_max_f32 v87, v87, v115
    v_max_f32 v88, v88, v116
    v_max_f32 v89, v89, v117
    v_max_f32 v90, v90, v118
    v_max_f32 v91, v91, v119
    v_max_f32 v92, v92, v120
    v_max_f32 v93, v93, v121
    v_max_f32 v94, v94, v122
    v_max_f32 v95, v95, v123
    v_max_f32 v96, v96, v124
    v_max_f32 v97, v97, v125
    v_max_f32 v98, v98, v126
    v_max_f32 v99, v99, v127
    s_add_u32 s65, s65, 4096
    s_cmp_lt_u32 s65, 262144
    s_cbranch_scc1 K1_FBLOOP
    v_max_f32 v80, v80, v81
    v_max3_f32 v80, v80, v82, v83
    v_mov_b32 v9, v80
    s_nop 1
    v_permlane32_swap_b32 v80, v9
    v_max_f32 v80, v80, v9
    v_mov_b32 v9, v80
    s_nop 1
    v_permlane16_swap_b32 v80, v9
    v_max_f32 v80, v80, v9
    v_xor_b32 v83, 0x80000000, v80
    v_xor_b32 v82, 0x80000000, v80
    v_xor_b32 v81, 0x80000000, v80
    v_xor_b32 v80, 0x80000000, v80
    v_max_f32 v84, v84, v85
    v_max3_f32 v84, v84, v86, v87
    v_mov_b32 v9, v84
    s_nop 1
    v_permlane32_swap_b32 v84, v9
    v_max_f32 v84, v84, v9
    v_mov_b32 v9, v84
    s_nop 1
    v_permlane16_swap_b32 v84, v9
    v_max_f32 v84, v84, v9
    v_xor_b32 v87, 0x80000000, v84
    v_xor_b32 v86, 0x80000000, v84
    v_xor_b32 v85, 0x80000000, v84
    v_xor_b32 v84, 0x80000000, v84
    v_max_f32 v88, v88, v89
    v_max3_f32 v88, v88, v90, v91
    v_mov_b32 v9, v88
    s_nop 1
    v_permlane32_swap_b32 v88, v9
    v_max_f32 v88, v88, v9
    v_mov_b32 v9, v88
    s_nop 1
    v_permlane16_swap_b32 v88, v9
    v_max_f32 v88, v88, v9
    v_xor_b32 v91, 0x80000000, v88
    v_xor_b32 v90, 0x80000000, v88
    v_xor_b32 v89, 0x80000000, v88
    v_xor_b32 v88, 0x80000000, v88
    v_max_f32 v92, v92, v93
    v_max3_f32 v92, v92, v94, v95
    v_mov_b32 v9, v92
    s_nop 1
    v_permlane32_swap_b32 v92, v9
    v_max_f32 v92, v92, v9
    v_mov_b32 v9, v92
    s_nop 1
    v_permlane16_swap_b32 v92, v9
    v_max_f32 v92, v92, v9
    v_xor_b32 v95, 0x80000000, v92
    v_xor_b32 v94, 0x80000000, v92
    v_xor_b32 v93, 0x80000000, v92
    v_xor_b32 v92, 0x80000000, v92
    v_max_f32 v96, v96, v97
    v_max3_f32 v96, v96, v98, v99
    v_mov_b32 v9, v96
    s_nop 1
    v_permlane32_swap_b32 v96, v9
    v_max_f32 v96, v96, v9
    v_mov_b32 v9, v96
    s_nop 1
    v_permlane16_swap_b32 v96, v9
    v_max_f32 v96, v96, v9
    v_xor_b32 v99, 0x80000000, v96
    v_xor_b32 v98, 0x80000000, v96
    v_xor_b32 v97, 0x80000000, v96
    v_xor_b32 v96, 0x80000000, v96
    v_and_b32 v9, 15, v0
    v_bfe_u32 v10, v0, 4, 2
    v_mul_u32_u24 v11, 1056, v9
    v_lshl_add_u32 v11, v10, 4, v11
    v_add_u32 v11, 101376, v11
    s_lshl_b32 s63, s25, 9
    s_xor_b32 s64, s63, 512
    s_lshl_b32 s65, s25, 7
    s_xor_b32 s66, s65, 128
    v_add_u32 v12, s63, v11
    v_add_u32 v1, s65, v12
    v_add_u32 v2, s66, v12
    v_add_u32 v12, s64, v11
    v_add_u32 v3, s65, v12
    v_add_u32 v4, s66, v12
    v_bfe_u32 v9, v0, 2, 4
    v_and_b32 v10, 3, v0
    v_mul_u32_u24 v11, 1056, v9
    v_lshl_add_u32 v11, v10, 3, v11
    v_add_u32 v5, s63, v11
    v_add_u32 v6, s64, v11
    s_mov_b32 s35, s67
    s_add_u32 s34, s67, 67584
    s_xor_b32 s36, s34, s35
    s_mov_b32 s38, 16384
    s_mov_b32 s39, 32768
    s_xor_b32 s49, s38, s48
    s_xor_b32 s69, s39, s48
    s_xor_b32 s63, s48, 0
    s_add_u32 m0, s67, 135168
    s_nop 0
    buffer_load_dwordx4 v7, s[12:15], s63 offen offset:0 nt lds
    s_add_u32 m0, s67, 135200
    s_nop 0
    buffer_load_dwordx4 v7, s[12:15], s63 offen offset:1024 nt lds
    s_add_u32 m0, s67, 135232
    s_nop 0
    buffer_load_dwordx4 v7, s[12:15], s63 offen offset:2048 nt lds
    s_add_u32 m0, s67, 135264
    s_nop 0
    buffer_load_dwordx4 v7, s[12:15], s63 offen offset:3072 nt lds
    s_xor_b32 s63, s48, 16384
    s_add_u32 m0, s67, 0
    s_nop 0
    buffer_load_dwordx4 v7, s[12:15], s63 offen offset:0 nt lds
    s_add_u32 m0, s67, 32
    s_nop 0
    buffer_load_dwordx4 v7, s[12:15], s63 offen offset:1024 nt lds
    s_add_u32 m0, s67, 64
    s_nop 0
    buffer_load_dwordx4 v7, s[12:15], s63 offen offset:2048 nt lds
    s_add_u32 m0, s67, 96
    s_nop 0
    buffer_load_dwordx4 v7, s[12:15], s63 offen offset:3072 nt lds
    s_xor_b32 s63, s48, 0
    s_add_u32 m0, s67, 16896
    s_nop 0
    buffer_load_dwordx4 v7, s[16:19], s63 offen offset:0 nt lds
    s_add_u32 m0, s67, 16928
    s_nop 0
    buffer_load_dwordx4 v7, s[16:19], s63 offen offset:1024 nt lds
    s_add_u32 m0, s67, 16960
    s_nop 0
    buffer_load_dwordx4 v7, s[16:19], s63 offen offset:2048 nt lds
    s_add_u32 m0, s67, 16992
    s_nop 0
    buffer_load_dwordx4 v7, s[16:19], s63 offen offset:3072 nt lds
    s_xor_b32 s63, s48, 16384
    s_add_u32 m0, s67, 50688
    s_nop 0
    buffer_load_dwordx4 v7, s[16:19], s63 offen offset:0 nt lds
    s_add_u32 m0, s67, 50720
    s_nop 0
    buffer_load_dwordx4 v7, s[16:19], s63 offen offset:1024 nt lds
    v_mov_b32 v100, 0
    v_mov_b32 v101, 0
    v_mov_b32 v102, 0
    v_mov_b32 v103, 0
    v_mov_b32 v104, 0
    v_accvgpr_write_b32 a0, 0
    v_accvgpr_write_b32 a1, 0
    v_accvgpr_write_b32 a2, 0
    v_accvgpr_write_b32 a3, 0
    v_accvgpr_write_b32 a4, 0
    v_accvgpr_write_b32 a5, 0
    v_accvgpr_write_b32 a6, 0
    v_accvgpr_write_b32 a7, 0
    v_accvgpr_write_b32 a8, 0
    v_accvgpr_write_b32 a9, 0
    v_accvgpr_write_b32 a10, 0
    v_accvgpr_write_b32 a11, 0
    v_accvgpr_write_b32 a12, 0
    v_accvgpr_write_b32 a13, 0
    v_accvgpr_write_b32 a14, 0
    v_accvgpr_write_b32 a15, 0
    v_accvgpr_write_b32 a16, 0
    v_accvgpr_write_b32 a17, 0
    v_accvgpr_write_b32 a18, 0
    v_accvgpr_write_b32 a19, 0
    v_accvgpr_write_b32 a20, 0
    v_accvgpr_write_b32 a21, 0
    v_accvgpr_write_b32 a22, 0
    v_accvgpr_write_b32 a23, 0
    v_accvgpr_write_b32 a24, 0
    v_accvgpr_write_b32 a25, 0
    v_accvgpr_write_b32 a26, 0
    v_accvgpr_write_b32 a27, 0
    v_accvgpr_write_b32 a28, 0
    v_accvgpr_write_b32 a29, 0
    v_accvgpr_write_b32 a30, 0
    v_accvgpr_write_b32 a31, 0
    v_accvgpr_write_b32 a32, 0
    v_accvgpr_write_b32 a33, 0
    v_accvgpr_write_b32 a34, 0
    v_accvgpr_write_b32 a35, 0
    v_accvgpr_write_b32 a36, 0
    v_accvgpr_write_b32 a37, 0
    v_accvgpr_write_b32 a38, 0
    v_accvgpr_write_b32 a39, 0
    v_accvgpr_write_b32 a40, 0
    v_accvgpr_write_b32 a41, 0
    v_accvgpr_write_b32 a42, 0
    v_accvgpr_write_b32 a43, 0
    v_accvgpr_write_b32 a44, 0
    v_accvgpr_write_b32 a45, 0
    v_accvgpr_write_b32 a46, 0
    v_accvgpr_write_b32 a47, 0
    v_accvgpr_write_b32 a48, 0
    v_accvgpr_write_b32 a49, 0
    v_accvgpr_write_b32 a50, 0
    v_accvgpr_write_b32 a51, 0
    v_accvgpr_write_b32 a52, 0
    v_accvgpr_write_b32 a53, 0
    v_accvgpr_write_b32 a54, 0
    v_accvgpr_write_b32 a55, 0
    v_accvgpr_write_b32 a56, 0
    v_accvgpr_write_b32 a57, 0
    v_accvgpr_write_b32 a58, 0
    v_accvgpr_write_b32 a59, 0
    v_accvgpr_write_b32 a60, 0
    v_accvgpr_write_b32 a61, 0
    v_accvgpr_write_b32 a62, 0
    v_accvgpr_write_b32 a63, 0
    v_accvgpr_write_b32 a64, 0
    v_accvgpr_write_b32 a65, 0
    v_accvgpr_write_b32 a66, 0
    v_accvgpr_write_b32 a67, 0
    v_accvgpr_write_b32 a68, 0
    v_accvgpr_write_b32 a69, 0
    v_accvgpr_write_b32 a70, 0
    v_accvgpr_write_b32 a71, 0
    v_accvgpr_write_b32 a72, 0
    v_accvgpr_write_b32 a73, 0
    v_accvgpr_write_b32 a74, 0
    v_accvgpr_write_b32 a75, 0
    v_accvgpr_write_b32 a76, 0
    v_accvgpr_write_b32 a77, 0
    v_accvgpr_write_b32 a78, 0
    v_accvgpr_write_b32 a79, 0
    v_accvgpr_write_b32 a80, 0
    v_accvgpr_write_b32 a81, 0
    v_accvgpr_write_b32 a82, 0
    v_accvgpr_write_b32 a83, 0
    v_accvgpr_write_b32 a84, 0
    v_accvgpr_write_b32 a85, 0
    v_accvgpr_write_b32 a86, 0
    v_accvgpr_write_b32 a87, 0
    v_accvgpr_write_b32 a88, 0
    v_accvgpr_write_b32 a89, 0
    v_accvgpr_write_b32 a90, 0
    v_accvgpr_write_b32 a91, 0
    v_accvgpr_write_b32 a92, 0
    v_accvgpr_write_b32 a93, 0
    v_accvgpr_write_b32 a94, 0
    v_accvgpr_write_b32 a95, 0
    v_accvgpr_write_b32 a96, 0
    v_accvgpr_write_b32 a97, 0
    v_accvgpr_write_b32 a98, 0
    v_accvgpr_write_b32 a99, 0
    v_accvgpr_write_b32 a100, 0
    v_accvgpr_write_b32 a101, 0
    v_accvgpr_write_b32 a102, 0
    v_accvgpr_write_b32 a103, 0
    v_accvgpr_write_b32 a104, 0
    v_accvgpr_write_b32 a105, 0
    v_accvgpr_write_b32 a106, 0
    v_accvgpr_write_b32 a107, 0
    v_accvgpr_write_b32 a108, 0
    v_accvgpr_write_b32 a109, 0
    v_accvgpr_write_b32 a110, 0
    v_accvgpr_write_b32 a111, 0
    v_accvgpr_write_b32 a112, 0
    v_accvgpr_write_b32 a113, 0
    v_accvgpr_write_b32 a114, 0
    v_accvgpr_write_b32 a115, 0
    v_accvgpr_write_b32 a116, 0
    v_accvgpr_write_b32 a117, 0
    v_accvgpr_write_b32 a118, 0
    v_accvgpr_write_b32 a119, 0
    v_accvgpr_write_b32 a120, 0
    v_accvgpr_write_b32 a121, 0
    v_accvgpr_write_b32 a122, 0
    v_accvgpr_write_b32 a123, 0
    v_accvgpr_write_b32 a124, 0
    v_accvgpr_write_b32 a125, 0
    v_accvgpr_write_b32 a126, 0
    v_accvgpr_write_b32 a127, 0
    v_accvgpr_write_b32 a128, 0
    v_accvgpr_write_b32 a129, 0
    v_accvgpr_write_b32 a130, 0
    v_accvgpr_write_b32 a131, 0
    v_accvgpr_write_b32 a132, 0
    v_accvgpr_write_b32 a133, 0
    v_accvgpr_write_b32 a134, 0
    v_accvgpr_write_b32 a135, 0
    v_accvgpr_write_b32 a136, 0
    v_accvgpr_write_b32 a137, 0
    v_accvgpr_write_b32 a138, 0
    v_accvgpr_write_b32 a139, 0
    v_accvgpr_write_b32 a140, 0
    v_accvgpr_write_b32 a141, 0
    v_accvgpr_write_b32 a142, 0
    v_accvgpr_write_b32 a143, 0
    v_accvgpr_write_b32 a144, 0
    v_accvgpr_write_b32 a145, 0
    v_accvgpr_write_b32 a146, 0
    v_accvgpr_write_b32 a147, 0
    v_accvgpr_write_b32 a148, 0
    v_accvgpr_write_b32 a149, 0
    v_accvgpr_write_b32 a150, 0
    v_accvgpr_write_b32 a151, 0
    v_accvgpr_write_b32 a152, 0
    v_accvgpr_write_b32 a153, 0
    v_accvgpr_write_b32 a154, 0
    v_accvgpr_write_b32 a155, 0
    v_accvgpr_write_b32 a156, 0
    v_accvgpr_write_b32 a157, 0
    v_accvgpr_write_b32 a158, 0
    v_accvgpr_write_b32 a159, 0
    v_accvgpr_write_b32 a236, 0
    v_accvgpr_write_b32 a237, 0
    v_accvgpr_write_b32 a238, 0
    v_accvgpr_write_b32 a239, 0
    v_accvgpr_write_b32 a240, 0
    v_accvgpr_write_b32 a241, 0
    v_accvgpr_write_b32 a242, 0
    v_accvgpr_write_b32 a243, 0
    v_accvgpr_write_b32 a244, 0
    v_accvgpr_write_b32 a245, 0
    v_accvgpr_write_b32 a246, 0
    v_accvgpr_write_b32 a247, 0
    v_accvgpr_write_b32 a248, 0
    v_accvgpr_write_b32 a249, 0
    v_accvgpr_write_b32 a250, 0
    v_accvgpr_write_b32 a251, 0
    v_accvgpr_write_b32 a252, 0
    v_accvgpr_write_b32 a253, 0
    v_accvgpr_write_b32 a254, 0
    v_accvgpr_write_b32 a255, 0
    s_waitcnt vmcnt(0) lgkmcnt(0)
    s_barrier
    ds_read_b128 a[160:163], v1 offset:33792
    ds_read_b128 a[164:167], v1 offset:33856
    ds_read_b128 a[168:171], v2 offset:33792
    ds_read_b128 a[172:175], v2 offset:33856
    s_waitcnt lgkmcnt(0)
    s_nop 7
    s_branch K1_ATT

.globl reduce_kernel
.p2align 8
.type reduce_kernel,@function
reduce_kernel:
    s_cmp_ge_u32 s2, 216
    s_cbranch_scc1 K2_END
    s_load_dwordx2 s[46:47], s[0:1], 80
    s_load_dwordx2 s[48:49], s[0:1], 96
    v_lshrrev_b32 v1, 6, v0
    v_and_b32 v0, 63, v0
    v_readfirstlane_b32 s24, v1
    v_lshlrev_b32 v2, 4, v0
    s_mul_i32 s25, s2, 12
    s_add_u32 s25, s25, s24
    s_mul_i32 s26, s25, 6473
    s_lshr_b32 s26, s26, 20
    s_mul_i32 s27, s26, 162
    s_sub_u32 s27, s25, s27
    s_mul_i32 s28, s26, 2654208
    s_lshl_b32 s29, s27, 10
    s_add_u32 s28, s28, s29
    s_add_u32 s28, s28, 67108864
    s_mov_b32 s6, 2489344
    s_mov_b32 s7, 0x00020000
    s_mov_b32 s30, 0
    s_waitcnt lgkmcnt(0)
    s_add_u32 s4, s48, s28
    s_addc_u32 s5, s49, 0
    buffer_load_dwordx4 v[16:19], v2, s[4:7], s30 offen
    s_add_u32 s30, s30, 165888
    buffer_load_dwordx4 v[20:23], v2, s[4:7], s30 offen
    s_add_u32 s30, s30, 165888
    buffer_load_dwordx4 v[24:27], v2, s[4:7], s30 offen
    s_add_u32 s30, s30, 165888
    buffer_load_dwordx4 v[28:31], v2, s[4:7], s30 offen
    s_add_u32 s30, s30, 165888
    buffer_load_dwordx4 v[32:35], v2, s[4:7], s30 offen
    s_add_u32 s30, s30, 165888
    buffer_load_dwordx4 v[36:39], v2, s[4:7], s30 offen
    s_add_u32 s30, s30, 165888
    buffer_load_dwordx4 v[40:43], v2, s[4:7], s30 offen
    s_add_u32 s30, s30, 165888
    buffer_load_dwordx4 v[44:47], v2, s[4:7], s30 offen
    s_add_u32 s30, s30, 165888
    buffer_load_dwordx4 v[48:51], v2, s[4:7], s30 offen
    s_add_u32 s30, s30, 165888
    buffer_load_dwordx4 v[52:55], v2, s[4:7], s30 offen
    s_add_u32 s30, s30, 165888
    buffer_load_dwordx4 v[56:59], v2, s[4:7], s30 offen
    s_add_u32 s30, s30, 165888
    buffer_load_dwordx4 v[60:63], v2, s[4:7], s30 offen
    s_add_u32 s30, s30, 165888
    buffer_load_dwordx4 v[64:67], v2, s[4:7], s30 offen
    s_add_u32 s30, s30, 165888
    buffer_load_dwordx4 v[68:71], v2, s[4:7], s30 offen
    s_add_u32 s30, s30, 165888
    buffer_load_dwordx4 v[72:75], v2, s[4:7], s30 offen
    s_add_u32 s30, s30, 165888
    buffer_load_dwordx4 v[76:79], v2, s[4:7], s30 offen
    s_and_b32 s28, s26, 7
    s_lshr_b32 s29, s26, 3
    s_mul_i32 s28, s28, 331776
    s_mul_i32 s29, s29, 1152
    s_add_u32 s28, s28, s29
    s_add_u32 s8, s46, s28
    s_addc_u32 s9, s47, 0
    s_sub_u32 s10, 2654208, s28
    s_mov_b32 s11, 0x00020000
    s_mov_b32 s32, 0x3f80
    s_mov_b32 s33, 0x3f800000
    s_cmp_ge_u32 s27, 144
    s_cbranch_scc1 K3_SH
    s_lshr_b32 s28, s27, 4
    s_lshl_b32 s28, s28, 7
    s_bfe_u32 s29, s27, 0x20002
    s_lshl_b32 s31, s29, 5
    s_add_u32 s28, s28, s31
    s_and_b32 s29, s27, 7
    s_mul_i32 s29, s29, 36864
    s_add_u32 s28, s28, s29
    s_xor_b32 s29, s28, 32
    v_and_b32 v5, 15, v0
    v_mul_u32_u24 v5, 2304, v5
    v_lshrrev_b32 v6, 4, v0
    v_lshl_add_u32 v5, v6, 3, v5
    v_add_u32 v3, s29, v5
    v_add_u32 v4, s28, v5
    s_branch K3_SUM
K3_SH:
    s_sub_u32 s28, s27, 144
    s_lshl_b32 s28, s28, 6
    s_add_u32 s28, s28, 294912
    v_and_b32 v5, 7, v0
    v_mul_u32_u24 v5, 4608, v5
    v_lshrrev_b32 v6, 3, v0
    v_lshl_add_u32 v5, v6, 3, v5
    v_add_u32 v3, s28, v5
    v_add_u32 v4, 2304, v3
K3_SUM:
    s_waitcnt vmcnt(15)
    v_dot2_f32_bf16 v8, v16, s32, 0
    v_dot2_f32_bf16 v9, v16, s33, 0
    v_dot2_f32_bf16 v10, v17, s32, 0
    v_dot2_f32_bf16 v11, v17, s33, 0
    v_dot2_f32_bf16 v12, v18, s32, 0
    v_dot2_f32_bf16 v13, v18, s33, 0
    v_dot2_f32_bf16 v14, v19, s32, 0
    v_dot2_f32_bf16 v15, v19, s33, 0
    s_waitcnt vmcnt(14)
    v_dot2_f32_bf16 v8, v20, s32, v8
    v_dot2_f32_bf16 v9, v20, s33, v9
    v_dot2_f32_bf16 v10, v21, s32, v10
    v_dot2_f32_bf16 v11, v21, s33, v11
    v_dot2_f32_bf16 v12, v22, s32, v12
    v_dot2_f32_bf16 v13, v22, s33, v13
    v_dot2_f32_bf16 v14, v23, s32, v14
    v_dot2_f32_bf16 v15, v23, s33, v15
    s_waitcnt vmcnt(13)
    v_dot2_f32_bf16 v8, v24, s32, v8
    v_dot2_f32_bf16 v9, v24, s33, v9
    v_dot2_f32_bf16 v10, v25, s32, v10
    v_dot2_f32_bf16 v11, v25, s33, v11
    v_dot2_f32_bf16 v12, v26, s32, v12
    v_dot2_f32_bf16 v13, v26, s33, v13
    v_dot2_f32_bf16 v14, v27, s32, v14
    v_dot2_f32_bf16 v15, v27, s33, v15
    s_waitcnt vmcnt(12)
    v_dot2_f32_bf16 v8, v28, s32, v8
    v_dot2_f32_bf16 v9, v28, s33, v9
    v_dot2_f32_bf16 v10, v29, s32, v10
    v_dot2_f32_bf16 v11, v29, s33, v11
    v_dot2_f32_bf16 v12, v30, s32, v12
    v_dot2_f32_bf16 v13, v30, s33, v13
    v_dot2_f32_bf16 v14, v31, s32, v14
    v_dot2_f32_bf16 v15, v31, s33, v15
    s_waitcnt vmcnt(11)
    v_dot2_f32_bf16 v8, v32, s32, v8
    v_dot2_f32_bf16 v9, v32, s33, v9
    v_dot2_f32_bf16 v10, v33, s32, v10
    v_dot2_f32_bf16 v11, v33, s33, v11
    v_dot2_f32_bf16 v12, v34, s32, v12
    v_dot2_f32_bf16 v13, v34, s33, v13
    v_dot2_f32_bf16 v14, v35, s32, v14
    v_dot2_f32_bf16 v15, v35, s33, v15
    s_waitcnt vmcnt(10)
    v_dot2_f32_bf16 v8, v36, s32, v8
    v_dot2_f32_bf16 v9, v36, s33, v9
    v_dot2_f32_bf16 v10, v37, s32, v10
    v_dot2_f32_bf16 v11, v37, s33, v11
    v_dot2_f32_bf16 v12, v38, s32, v12
    v_dot2_f32_bf16 v13, v38, s33, v13
    v_dot2_f32_bf16 v14, v39, s32, v14
    v_dot2_f32_bf16 v15, v39, s33, v15
    s_waitcnt vmcnt(9)
    v_dot2_f32_bf16 v8, v40, s32, v8
    v_dot2_f32_bf16 v9, v40, s33, v9
    v_dot2_f32_bf16 v10, v41, s32, v10
    v_dot2_f32_bf16 v11, v41, s33, v11
    v_dot2_f32_bf16 v12, v42, s32, v12
    v_dot2_f32_bf16 v13, v42, s33, v13
    v_dot2_f32_bf16 v14, v43, s32, v14
    v_dot2_f32_bf16 v15, v43, s33, v15
    s_waitcnt vmcnt(8)
    v_dot2_f32_bf16 v8, v44, s32, v8
    v_dot2_f32_bf16 v9, v44, s33, v9
    v_dot2_f32_bf16 v10, v45, s32, v10
    v_dot2_f32_bf16 v11, v45, s33, v11
    v_dot2_f32_bf16 v12, v46, s32, v12
    v_dot2_f32_bf16 v13, v46, s33, v13
    v_dot2_f32_bf16 v14, v47, s32, v14
    v_dot2_f32_bf16 v15, v47, s33, v15
    s_waitcnt vmcnt(7)
    v_dot2_f32_bf16 v8, v48, s32, v8
    v_dot2_f32_bf16 v9, v48, s33, v9
    v_dot2_f32_bf16 v10, v49, s32, v10
    v_dot2_f32_bf16 v11, v49, s33, v11
    v_dot2_f32_bf16 v12, v50, s32, v12
    v_dot2_f32_bf16 v13, v50, s33, v13
    v_dot2_f32_bf16 v14, v51, s32, v14
    v_dot2_f32_bf16 v15, v51, s33, v15
    s_waitcnt vmcnt(6)
    v_dot2_f32_bf16 v8, v52, s32, v8
    v_dot2_f32_bf16 v9, v52, s33, v9
    v_dot2_f32_bf16 v10, v53, s32, v10
    v_dot2_f32_bf16 v11, v53, s33, v11
    v_dot2_f32_bf16 v12, v54, s32, v12
    v_dot2_f32_bf16 v13, v54, s33, v13
    v_dot2_f32_bf16 v14, v55, s32, v14
    v_dot2_f32_bf16 v15, v55, s33, v15
    s_waitcnt vmcnt(5)
    v_dot2_f32_bf16 v8, v56, s32, v8
    v_dot2_f32_bf16 v9, v56, s33, v9
    v_dot2_f32_bf16 v10, v57, s32, v10
    v_dot2_f32_bf16 v11, v57, s33, v11
    v_dot2_f32_bf16 v12, v58, s32, v12
    v_dot2_f32_bf16 v13, v58, s33, v13
    v_dot2_f32_bf16 v14, v59, s32, v14
    v_dot2_f32_bf16 v15, v59, s33, v15
    s_waitcnt vmcnt(4)
    v_dot2_f32_bf16 v8, v60, s32, v8
    v_dot2_f32_bf16 v9, v60, s33, v9
    v_dot2_f32_bf16 v10, v61, s32, v10
    v_dot2_f32_bf16 v11, v61, s33, v11
    v_dot2_f32_bf16 v12, v62, s32, v12
    v_dot2_f32_bf16 v13, v62, s33, v13
    v_dot2_f32_bf16 v14, v63, s32, v14
    v_dot2_f32_bf16 v15, v63, s33, v15
    s_waitcnt vmcnt(3)
    v_dot2_f32_bf16 v8, v64, s32, v8
    v_dot2_f32_bf16 v9, v64, s33, v9
    v_dot2_f32_bf16 v10, v65, s32, v10
    v_dot2_f32_bf16 v11, v65, s33, v11
    v_dot2_f32_bf16 v12, v66, s32, v12
    v_dot2_f32_bf16 v13, v66, s33, v13
    v_dot2_f32_bf16 v14, v67, s32, v14
    v_dot2_f32_bf16 v15, v67, s33, v15
    s_waitcnt vmcnt(2)
    v_dot2_f32_bf16 v8, v68, s32, v8
    v_dot2_f32_bf16 v9, v68, s33, v9
    v_dot2_f32_bf16 v10, v69, s32, v10
    v_dot2_f32_bf16 v11, v69, s33, v11
    v_dot2_f32_bf16 v12, v70, s32, v12
    v_dot2_f32_bf16 v13, v70, s33, v13
    v_dot2_f32_bf16 v14, v71, s32, v14
    v_dot2_f32_bf16 v15, v71, s33, v15
    s_waitcnt vmcnt(1)
    v_dot2_f32_bf16 v8, v72, s32, v8
    v_dot2_f32_bf16 v9, v72, s33, v9
    v_dot2_f32_bf16 v10, v73, s32, v10
    v_dot2_f32_bf16 v11, v73, s33, v11
    v_dot2_f32_bf16 v12, v74, s32, v12
    v_dot2_f32_bf16 v13, v74, s33, v13
    v_dot2_f32_bf16 v14, v75, s32, v14
    v_dot2_f32_bf16 v15, v75, s33, v15
    s_waitcnt vmcnt(0)
    v_dot2_f32_bf16 v8, v76, s32, v8
    v_dot2_f32_bf16 v9, v76, s33, v9
    v_dot2_f32_bf16 v10, v77, s32, v10
    v_dot2_f32_bf16 v11, v77, s33, v11
    v_dot2_f32_bf16 v12, v78, s32, v12
    v_dot2_f32_bf16 v13, v78, s33, v13
    v_dot2_f32_bf16 v14, v79, s32, v14
    v_dot2_f32_bf16 v15, v79, s33, v15
    s_nop 3
    v_cvt_pk_bf16_f32 v8, v8, v9
    v_cvt_pk_bf16_f32 v9, v10, v11
    v_cvt_pk_bf16_f32 v10, v12, v13
    v_cvt_pk_bf16_f32 v11, v14, v15
    buffer_store_dwordx2 v[8:9], v3, s[8:11], 0 offen
    buffer_store_dwordx2 v[10:11], v4, s[8:11], 0 offen
K2_END:
    s_endpgm

.section .rodata,"a"
.p2align 6
.amdhsa_kernel attn_kernel
  .amdhsa_next_free_vgpr 512
  .amdhsa_next_free_sgpr 102
  .amdhsa_accum_offset 256
  .amdhsa_group_segment_fixed_size 0
  .amdhsa_kernarg_size 104
  .amdhsa_user_sgpr_count 2
  .amdhsa_user_sgpr_kernarg_segment_ptr 1
  .amdhsa_system_sgpr_workgroup_id_x 1
.end_amdhsa_kernel
.p2align 6
.amdhsa_kernel reduce_kernel
  .amdhsa_next_free_vgpr 80
  .amdhsa_next_free_sgpr 102
  .amdhsa_accum_offset 80
  .amdhsa_group_segment_fixed_size 0
  .amdhsa_kernarg_size 104
  .amdhsa_user_sgpr_count 2
  .amdhsa_user_sgpr_kernarg_segment_ptr 1
  .amdhsa_system_sgpr_workgroup_id_x 1
.end_amdhsa_kernel
```
